```python
import torch

def _softmax(x, axis=-1):
    return torch.softmax(x, dim=axis)
def _gelu(x):
    return torch.nn.functional.gelu(x, approximate="tanh")
def _silu(x):
    return torch.nn.functional.silu(x)
def _sigmoid(x):
    return torch.sigmoid(x)
def _layernorm(x, axis=-1, eps=1e-5):
    m = x.mean(dim=axis, keepdim=True)
    v = x.var(dim=axis, keepdim=True, unbiased=False)
    return (x - m) / torch.sqrt(v + eps)
def _scatter_add(tgt, idx, src, axis=0):
    return tgt.clone().index_add_(axis, idx, src)
def _segment_sum(src, seg, n):
    out = torch.zeros((n,) + src.shape[1:], dtype=src.dtype)
    return out.index_add_(0, seg, src)
def _pad(x, pw):
    flat = tuple(v for pair in reversed(pw) for v in pair)
    return torch.nn.functional.pad(x, flat)

kernel_name = 'standalone__kv_cache_quant_int4_int2_kv_with_per_channel_or_per_token_scales__sampling'

def setup_inputs():

    _w = (lambda a: (lambda t: t.to(torch.bfloat16) if t.is_floating_point() else t)(torch.as_tensor(a)))
    B = 32
    Sq = 1
    Skv = 2048
    Hq = 32
    Hkv = 16
    Dh = 128
    bits = 4
    G = 32
    if G <= 0 or G >= Skv:
        G = max(1, Skv // 2)
    Skv = (Skv // G) * G
    ngk = Skv // G
    qmax = (1 << bits) - 1
    return {
        "q": _w((lambda *s: torch.randn(*s, dtype=torch.bfloat16) * 1.6)(B, Hq, Sq, Dh)),
        "qk": _w(torch.randint(0, qmax + 1, (B, Hkv, Skv, Dh)).to(torch.int32)),
        "qv": _w(torch.randint(0, qmax + 1, (B, Hkv, Skv, Dh)).to(torch.int32)),
        "k_scales": _w(torch.abs((lambda *s: torch.randn(*s, dtype=torch.bfloat16) * 1.6)(B, Hkv, ngk, Dh)) * 0.05 + 0.02),
        "k_zeros": _w((lambda *s: torch.randn(*s, dtype=torch.bfloat16) * 1.6)(B, Hkv, ngk, Dh) + float(qmax) / 2.0),
        "v_scales": _w(torch.abs((lambda *s: torch.randn(*s, dtype=torch.bfloat16) * 0.05)(B, Hkv, Skv, 1)) * 0.05 + 0.02),
        "v_zeros": _w((lambda *s: torch.randn(*s, dtype=torch.bfloat16) * 0.05)(B, Hkv, Skv, 1) + float(qmax) / 2.0),
    }

def reference(q, qk, qv, k_scales, k_zeros, v_scales, v_zeros):
    B, Hq, Sq, Dh = q.shape
    Hkv, Skv = qk.shape[1], qk.shape[2]
    ngk = k_scales.shape[2]
    G = Skv // ngk
    ks = (lambda x, n, axis: torch.repeat_interleave(x, n, dim=axis))(k_scales, G, axis=2)
    kz = (lambda x, n, axis: torch.repeat_interleave(x, n, dim=axis))(k_zeros, G, axis=2)
    k = ((lambda x, dt: x.to(dt))(qk, q.dtype) - kz) * ks
    v = ((lambda x, dt: x.to(dt))(qv, q.dtype) - v_zeros) * v_scales
    rep = Hq // Hkv
    if rep > 1:
        k = (lambda x, n, axis: torch.repeat_interleave(x, n, dim=axis))(k, rep, axis=1)
        v = (lambda x, n, axis: torch.repeat_interleave(x, n, dim=axis))(v, rep, axis=1)
    scale = float(Dh) ** -0.5
    logits = torch.einsum("bhqd,bhkd->bhqk", q, k) * scale
    p = _softmax(logits, axis=-1)
    o = torch.einsum("bhqk,bhkd->bhqd", p, v)
    return o
```

```asm
; @launch grid=(256,1,1) block=(320,1,1) lds=130304
.amdgcn_target "amdgcn-amd-amdhsa--gfx950"
.text
.globl standalone__kv_cache_quant_int4_int2_kv_with_per_channel_or_per_token_scales__sampling_kernel
.p2align 8
.type standalone__kv_cache_quant_int4_int2_kv_with_per_channel_or_per_token_scales__sampling_kernel,@function
standalone__kv_cache_quant_int4_int2_kv_with_per_channel_or_per_token_scales__sampling_kernel:
    s_cmp_ge_u32 s2, 256
    s_cbranch_scc1 L_end
    s_load_dwordx16 s[56:71], s[0:1], 0
    s_load_dwordx2 s[48:49], s[0:1], 64
    s_mov_b32 s27, 0
    s_mov_b32 s3, s2
    v_lshrrev_b32 v68, 6, v0
    v_and_b32 v0, 63, v0
    v_readfirstlane_b32 s21, v68
    v_lshlrev_b32 v71, 4, v0
    v_and_b32 v69, 31, v0
    v_lshlrev_b32 v2, 3, v69
    s_mov_b32 s11, 0x20000
    s_cmp_eq_u32 s21, 4
    s_cbranch_scc1 L_erest
    s_setprio 2
    s_waitcnt lgkmcnt(0)
    s_lshl_b32 s72, s2, 10
    s_add_u32 s8, s56, s72
    s_addc_u32 s9, s57, 0
    s_mov_b32 s10, 0x400
    buffer_load_dwordx2 v[36:37], v2, s[8:11], 0 offen offset:0
    buffer_load_dwordx2 v[38:39], v2, s[8:11], 0 offen offset:256
    buffer_load_dwordx2 v[40:41], v2, s[8:11], 0 offen offset:512
    buffer_load_dwordx2 v[42:43], v2, s[8:11], 0 offen offset:768
    s_lshl_b32 s72, s2, 15
    s_add_u32 s8, s62, s72
    s_addc_u32 s9, s63, 0
    s_mov_b32 s10, 0x8000
    s_mul_i32 s72, s21, 8192
    s_add_u32 m0, s72, 0
    s_nop 0
    buffer_load_dwordx4 v71, s[8:11], s72 offen offset:0 nt lds
    buffer_load_dwordx4 v71, s[8:11], s72 offen offset:1024 nt lds
    buffer_load_dwordx4 v71, s[8:11], s72 offen offset:2048 nt lds
    buffer_load_dwordx4 v71, s[8:11], s72 offen offset:3072 nt lds
    s_add_u32 s72, s72, 4096
    s_add_u32 m0, s72, 0
    s_nop 0
    buffer_load_dwordx4 v71, s[8:11], s72 offen offset:0 nt lds
    buffer_load_dwordx4 v71, s[8:11], s72 offen offset:1024 nt lds
L_erest:
    v_lshl_add_u32 v1, v68, 10, v71
    v_lshlrev_b32 v69, 2, v0
    v_lshl_add_u32 v4, v68, 8, v69
    v_add_u32 v4, 0x14000, v4
    v_and_b32 v69, 15, v0
    v_mul_u32_u24 v69, 4, v69
    v_add_u32 v69, v69, v68
    v_lshlrev_b32 v69, 2, v69
    v_lshrrev_b32 v70, 5, v0
    v_lshl_add_u32 v3, v70, 1, v69
    v_add_u32 v3, 0x10000, v3
    s_getreg_b32 s50, hwreg(HW_REG_XCC_ID, 0, 3)
    s_lshl_b32 s50, s50, 4
    v_mov_b32 v22, s50
    v_mov_b32 v27, 128
    v_mov_b32 v20, 1
    v_mov_b32 v21, 0
    v_mov_b32 v23, 0x1f800
    v_xor_b32 v25, 15, v0
    v_bfrev_b32 v25, v25
    v_lshrrev_b32 v25, 28, v25
    v_mul_u32_u24 v24, 0, v68
    v_add_u32 v25, v25, v24
    v_and_b32 v25, 15, v25
    s_mov_b32 s44, 16
    s_mov_b32 s45, -1
    s_mov_b32 s46, 0
    v_mov_b32 v24, 0
    s_lshr_b32 s51, s50, 2
    s_lshr_b32 s46, 0x1010101, s51
    s_and_b32 s46, s46, 15
    s_cmp_eq_u32 s21, 4
    s_cbranch_scc1 L_help
    v_lshl_add_u32 v23, v68, 2, v23
    v_mov_b32 v24, s46
    ds_write_b32 v23, v24
    v_lshlrev_b32 v22, 2, v0
    v_lshl_add_u32 v22, v68, 8, v22
    v_add_u32 v22, 0x1f900, v22
    ds_write_b32 v22, v21
    v_mov_b32 v80, 0x1c000
    v_lshl_add_u32 v80, v0, 4, v80
    v_lshl_add_u32 v78, v68, 2, v80
    v_mov_b32 v76, -1
    ds_write_b32 v78, v76 offset:5120
    ds_write_b32 v80, v21 offset:6144
    ds_write_b32 v78, v76 offset:12288
    ds_write_b32 v80, v21 offset:13312
    v_add_u32 v24, 0, v24
    v_cmp_gt_i32 s[52:53], v24, v25
    v_sub_u32 v24, 0, v24
    v_cmp_gt_i32 s[54:55], v24, v25
    s_mov_b32 s28, 0x1000
    s_mov_b32 s29, 0x2000
    s_mov_b32 s30, 0x3000
    s_mov_b32 s31, 0x4000
    s_mov_b32 s32, 0x5000
    s_mov_b32 s33, 0x6000
    s_mov_b32 s34, 0x7000
    s_mov_b32 s35, 0x8000
    s_mov_b32 s36, 0x9000
    s_mov_b32 s37, 0xa000
    s_mov_b32 s38, 0xb000
    s_mov_b32 s39, 0xc000
    s_mov_b32 s40, 0xd000
    s_mov_b32 s41, 0xe000
    s_mov_b32 s42, 0xf000
    s_mov_b32 s22, 0xcccccccc
    s_mov_b32 s23, 0xcccccccc
    s_mov_b32 s24, 0xaaaaaaaa
    s_mov_b32 s25, 0xaaaaaaaa
    s_mov_b32 s26, 0x3e0293ee
    s_mov_b32 s18, 0
    s_mov_b32 s7, 0x20000
    s_mov_b32 s15, 0x20000
    s_mov_b32 s6, 0x10000
    s_waitcnt vmcnt(5)
    buffer_load_dwordx4 v71, s[8:11], s72 offen offset:2048 nt lds
    s_waitcnt vmcnt(5)
    buffer_load_dwordx4 v71, s[8:11], s72 offen offset:3072 nt lds
    s_lshl_b32 s72, s2, 15
    s_add_u32 s8, s64, s72
    s_addc_u32 s9, s65, 0
    s_mov_b32 s10, 0x8000
    s_mul_i32 s72, s21, 8192
    s_add_u32 m0, s72, 32768
    s_nop 0
    s_waitcnt vmcnt(5)
    buffer_load_dwordx4 v71, s[8:11], s72 offen offset:0 nt lds
    s_waitcnt vmcnt(5)
    buffer_load_dwordx4 v71, s[8:11], s72 offen offset:1024 nt lds
    s_waitcnt vmcnt(5)
    buffer_load_dwordx4 v71, s[8:11], s72 offen offset:2048 nt lds
    s_waitcnt vmcnt(5)
    buffer_load_dwordx4 v71, s[8:11], s72 offen offset:3072 nt lds
    s_add_u32 s72, s72, 4096
    s_add_u32 m0, s72, 32768
    s_nop 0
    s_waitcnt vmcnt(5)
    buffer_load_dwordx4 v71, s[8:11], s72 offen offset:0 nt lds
    s_waitcnt vmcnt(5)
    buffer_load_dwordx4 v71, s[8:11], s72 offen offset:1024 nt lds
    s_waitcnt vmcnt(5)
    buffer_load_dwordx4 v71, s[8:11], s72 offen offset:2048 nt lds
    s_waitcnt vmcnt(5)
    buffer_load_dwordx4 v71, s[8:11], s72 offen offset:3072 nt lds
    s_lshl_b32 s72, s2, 13
    s_add_u32 s8, s66, s72
    s_addc_u32 s9, s67, 0
    s_mov_b32 s10, 0x2000
    s_mul_i32 s72, s21, 2048
    s_add_u32 m0, s72, 65536
    s_nop 0
    s_waitcnt vmcnt(5)
    buffer_load_dwordx4 v71, s[8:11], s72 offen offset:0 nt lds
    s_waitcnt vmcnt(5)
    buffer_load_dwordx4 v71, s[8:11], s72 offen offset:1024 nt lds
    s_lshl_b32 s72, s2, 13
    s_add_u32 s8, s68, s72
    s_addc_u32 s9, s69, 0
    s_mov_b32 s10, 0x2000
    s_mul_i32 s72, s21, 2048
    s_add_u32 m0, s72, 73728
    s_nop 0
    s_waitcnt vmcnt(5)
    buffer_load_dwordx4 v71, s[8:11], s72 offen offset:0 nt lds
    s_waitcnt vmcnt(5)
    buffer_load_dwordx4 v71, s[8:11], s72 offen offset:1024 nt lds
    s_lshl_b32 s72, s2, 21
    s_add_u32 s4, s58, s72
    s_addc_u32 s5, s59, 0
    s_lshl_b32 s72, s2, 21
    s_add_u32 s16, s60, s72
    s_addc_u32 s17, s61, 0
    s_waitcnt vmcnt(5)
    buffer_load_dwordx4 v[104:107], v1, s[4:7], 0 offen nt
    s_waitcnt vmcnt(5)
    buffer_load_dwordx4 v[108:111], v1, s[4:7], s28 offen nt
    s_waitcnt vmcnt(5)
    buffer_load_dwordx4 v[112:115], v1, s[4:7], s29 offen nt
    s_waitcnt vmcnt(5)
    buffer_load_dwordx4 v[116:119], v1, s[4:7], s30 offen nt
    s_waitcnt vmcnt(5)
    buffer_load_dwordx4 v[120:123], v1, s[4:7], s31 offen nt
    s_waitcnt vmcnt(5)
    buffer_load_dwordx4 v[124:127], v1, s[4:7], s32 offen nt
    s_waitcnt vmcnt(5)
    buffer_load_dwordx4 v[128:131], v1, s[4:7], s33 offen nt
    s_waitcnt vmcnt(5)
    buffer_load_dwordx4 v[132:135], v1, s[4:7], s34 offen nt
    s_waitcnt vmcnt(5)
    buffer_load_dwordx4 v[136:139], v1, s[4:7], s35 offen nt
    s_waitcnt vmcnt(5)
    buffer_load_dwordx4 v[140:143], v1, s[4:7], s36 offen nt
    s_waitcnt vmcnt(5)
    buffer_load_dwordx4 v[144:147], v1, s[4:7], s37 offen nt
    s_waitcnt vmcnt(5)
    buffer_load_dwordx4 v[148:151], v1, s[4:7], s38 offen nt
    s_waitcnt vmcnt(5)
    buffer_load_dwordx4 v[152:155], v1, s[4:7], s39 offen nt
    s_waitcnt vmcnt(5)
    buffer_load_dwordx4 v[156:159], v1, s[4:7], s40 offen nt
    s_waitcnt vmcnt(5)
    buffer_load_dwordx4 v[160:163], v1, s[4:7], s41 offen nt
    s_waitcnt vmcnt(5)
    buffer_load_dwordx4 v[164:167], v1, s[4:7], s42 offen nt
    s_lshl_b32 s72, s2, 10
    s_add_u32 s12, s70, s72
    s_addc_u32 s13, s71, 0
    s_mov_b32 s14, 0x400
    v_mov_b32 v9, 0
    v_mov_b32 v10, 0
    s_waitcnt vmcnt(16)
    s_waitcnt lgkmcnt(0)
    s_barrier
    ds_read_b64 v[28:29], v2 offset:0
    ds_read_b64 v[30:31], v2 offset:32768
    s_mov_b32 s20, 0
    s_mov_b32 s44, 0
L_kout:
    s_nop 0
    v_lshlrev_b32 v44, 16, v36
    v_and_b32 v45, 0xffff0000, v36
    v_lshlrev_b32 v46, 16, v37
    v_and_b32 v47, 0xffff0000, v37
    v_lshlrev_b32 v48, 16, v38
    v_and_b32 v49, 0xffff0000, v38
    v_lshlrev_b32 v50, 16, v39
    v_and_b32 v51, 0xffff0000, v39
    v_mul_f32 v44, s26, v44
    v_mul_f32 v45, s26, v45
    v_mul_f32 v46, s26, v46
    v_mul_f32 v47, s26, v47
    v_mul_f32 v48, s26, v48
    v_mul_f32 v49, s26, v49
    v_mul_f32 v50, s26, v50
    v_mul_f32 v51, s26, v51
    v_mov_b32 v36, v40
    v_mov_b32 v37, v41
    v_mov_b32 v38, v42
    v_mov_b32 v39, v43
    v_mov_b32 v5, 0xff800000
    s_mov_b32 s19, 16
    s_waitcnt lgkmcnt(0)
L_kloop_disp:
.p2align 6
L_kloop0:
    s_waitcnt vmcnt(15)
    v_cvt_f32_i32 v68, v104
    v_cvt_f32_i32 v69, v105
    v_cvt_f32_i32 v70, v106
    v_cvt_f32_i32 v71, v107
    ds_add_u32 v22, v20
    s_add_u32 s4, s4, 0x10000
    s_addc_u32 s5, s5, 0
    s_add_u32 s18, s18, 1
    s_cmp_eq_u32 s18, 32
    s_cselect_b32 s4, s16, s4
    s_cselect_b32 s5, s17, s5
    s_cmp_ge_u32 s18, 64
    s_cselect_b32 s6, 0, 0x10000
    s_bitcmp1_b32 s52, 0
    s_cbranch_scc1 L_wa1
    s_bitcmp1_b32 s54, 0
    s_cbranch_scc0 L_wb1
    s_waitcnt vmcnt(3)
L_wb1:
    s_waitcnt vmcnt(4)
L_wa1:
    s_waitcnt vmcnt(5)
    buffer_load_dwordx4 v[104:107], v1, s[4:7], 0 offen nt
    s_waitcnt lgkmcnt(3)
    s_waitcnt lgkmcnt(2)
    ds_read_b64 v[32:33], v2 offset:256
    ds_read_b64 v[34:35], v2 offset:33024
    v_lshlrev_b32 v76, 16, v28
    v_and_b32 v77, 0xffff0000, v28
    v_lshlrev_b32 v78, 16, v29
    v_and_b32 v79, 0xffff0000, v29
    v_lshlrev_b32 v80, 16, v30
    v_and_b32 v81, 0xffff0000, v30
    v_lshlrev_b32 v82, 16, v31
    v_and_b32 v83, 0xffff0000, v31
    v_mul_f32 v52, v44, v76
    v_mul_f32 v53, v45, v77
    v_mul_f32 v54, v46, v78
    v_mul_f32 v55, v47, v79
    v_mul_f32 v56, v48, v76
    v_mul_f32 v57, v49, v77
    v_mul_f32 v58, v50, v78
    v_mul_f32 v59, v51, v79
    v_mul_f32 v13, v52, v80
    v_mul_f32 v14, v56, v80
    v_fmac_f32 v13, v53, v81
    v_fmac_f32 v14, v57, v81
    v_fmac_f32 v13, v54, v82
    v_fmac_f32 v14, v58, v82
    v_fmac_f32 v13, v55, v83
    v_fmac_f32 v14, v59, v83
    v_fma_f32 v88, v52, v68, -v13
    v_fma_f32 v84, v56, v68, -v14
    v_fmac_f32 v88, v53, v69
    v_fmac_f32 v84, v57, v69
    v_fmac_f32 v88, v54, v70
    v_fmac_f32 v84, v58, v70
    v_fmac_f32 v88, v55, v71
    v_fmac_f32 v84, v59, v71
    s_waitcnt vmcnt(15)
    v_cvt_f32_i32 v72, v108
    v_cvt_f32_i32 v73, v109
    v_cvt_f32_i32 v74, v110
    v_cvt_f32_i32 v75, v111
    s_bitcmp1_b32 s52, 1
    s_cbranch_scc1 L_wa2
    s_bitcmp1_b32 s54, 1
    s_cbranch_scc0 L_wb2
    s_waitcnt vmcnt(3)
L_wb2:
    s_waitcnt vmcnt(4)
L_wa2:
    s_waitcnt vmcnt(5)
    buffer_load_dwordx4 v[108:111], v1, s[4:7], s28 offen nt
    v_fma_f32 v89, v52, v72, -v13
    v_fma_f32 v85, v56, v72, -v14
    v_permlane16_swap_b32 v88, v84
    v_add_f32 v88, v88, v84
    v_fmac_f32 v89, v53, v73
    v_fmac_f32 v85, v57, v73
    v_add_f32_dpp v88, v88, v88 row_mirror row_mask:0xf bank_mask:0x3
    v_fmac_f32 v89, v54, v74
    v_fmac_f32 v85, v58, v74
    v_fmac_f32 v89, v55, v75
    v_fmac_f32 v85, v59, v75
    s_waitcnt vmcnt(15)
    v_cvt_f32_i32 v68, v112
    v_cvt_f32_i32 v69, v113
    v_cvt_f32_i32 v70, v114
    v_cvt_f32_i32 v71, v115
    ds_add_u32 v22, v20
    s_bitcmp1_b32 s52, 2
    s_cbranch_scc1 L_wa3
    s_bitcmp1_b32 s54, 2
    s_cbranch_scc0 L_wb3
    s_waitcnt vmcnt(3)
L_wb3:
    s_waitcnt vmcnt(4)
L_wa3:
    s_waitcnt vmcnt(5)
    buffer_load_dwordx4 v[112:115], v1, s[4:7], s29 offen nt
    v_fma_f32 v90, v52, v68, -v13
    v_fma_f32 v84, v56, v68, -v14
    v_permlane16_swap_b32 v89, v85
    v_add_f32 v89, v89, v85
    v_fmac_f32 v90, v53, v69
    v_fmac_f32 v84, v57, v69
    v_add_f32_dpp v89, v89, v89 row_mirror row_mask:0xf bank_mask:0x3
    v_fmac_f32 v90, v54, v70
    v_fmac_f32 v84, v58, v70
    v_fmac_f32 v90, v55, v71
    v_fmac_f32 v84, v59, v71
    s_waitcnt vmcnt(15)
    v_cvt_f32_i32 v72, v116
    v_cvt_f32_i32 v73, v117
    v_cvt_f32_i32 v74, v118
    v_cvt_f32_i32 v75, v119
    s_bitcmp1_b32 s52, 3
    s_cbranch_scc1 L_wa4
    s_bitcmp1_b32 s54, 3
    s_cbranch_scc0 L_wb4
    s_waitcnt vmcnt(3)
L_wb4:
    s_waitcnt vmcnt(4)
L_wa4:
    s_waitcnt vmcnt(5)
    buffer_load_dwordx4 v[116:119], v1, s[4:7], s30 offen nt
    v_fma_f32 v91, v52, v72, -v13
    v_fma_f32 v85, v56, v72, -v14
    v_permlane16_swap_b32 v90, v84
    v_add_f32 v90, v90, v84
    v_fmac_f32 v91, v53, v73
    v_fmac_f32 v85, v57, v73
    v_add_f32_dpp v90, v90, v90 row_mirror row_mask:0xf bank_mask:0x3
    v_fmac_f32 v91, v54, v74
    v_fmac_f32 v85, v58, v74
    v_fmac_f32 v91, v55, v75
    v_fmac_f32 v85, v59, v75
    s_waitcnt vmcnt(15)
    v_cvt_f32_i32 v68, v120
    v_cvt_f32_i32 v69, v121
    v_cvt_f32_i32 v70, v122
    v_cvt_f32_i32 v71, v123
    ds_add_u32 v22, v20
    s_bitcmp1_b32 s52, 4
    s_cbranch_scc1 L_wa5
    s_bitcmp1_b32 s54, 4
    s_cbranch_scc0 L_wb5
    s_waitcnt vmcnt(3)
L_wb5:
    s_waitcnt vmcnt(4)
L_wa5:
    s_waitcnt vmcnt(5)
    buffer_load_dwordx4 v[120:123], v1, s[4:7], s31 offen nt
    s_waitcnt lgkmcnt(3)
    s_waitcnt lgkmcnt(2)
    ds_read_b64 v[28:29], v2 offset:512
    ds_read_b64 v[30:31], v2 offset:33280
    v_lshlrev_b32 v76, 16, v32
    v_and_b32 v77, 0xffff0000, v32
    v_lshlrev_b32 v78, 16, v33
    v_and_b32 v79, 0xffff0000, v33
    v_lshlrev_b32 v80, 16, v34
    v_and_b32 v81, 0xffff0000, v34
    v_lshlrev_b32 v82, 16, v35
    v_and_b32 v83, 0xffff0000, v35
    v_mul_f32 v52, v44, v76
    v_mul_f32 v53, v45, v77
    v_mul_f32 v54, v46, v78
    v_mul_f32 v55, v47, v79
    v_mul_f32 v56, v48, v76
    v_mul_f32 v57, v49, v77
    v_mul_f32 v58, v50, v78
    v_mul_f32 v59, v51, v79
    v_mul_f32 v13, v52, v80
    v_mul_f32 v14, v56, v80
    v_fmac_f32 v13, v53, v81
    v_fmac_f32 v14, v57, v81
    v_fmac_f32 v13, v54, v82
    v_fmac_f32 v14, v58, v82
    v_fmac_f32 v13, v55, v83
    v_fmac_f32 v14, v59, v83
    v_fma_f32 v92, v52, v68, -v13
    v_fma_f32 v84, v56, v68, -v14
    v_permlane16_swap_b32 v91, v85
    v_add_f32 v91, v91, v85
    v_fmac_f32 v92, v53, v69
    v_fmac_f32 v84, v57, v69
    v_add_f32_dpp v91, v91, v91 row_mirror row_mask:0xf bank_mask:0x3
    v_fmac_f32 v92, v54, v70
    v_fmac_f32 v84, v58, v70
    v_fmac_f32 v92, v55, v71
    v_fmac_f32 v84, v59, v71
    s_waitcnt vmcnt(15)
    v_cvt_f32_i32 v72, v124
    v_cvt_f32_i32 v73, v125
    v_cvt_f32_i32 v74, v126
    v_cvt_f32_i32 v75, v127
    s_bitcmp1_b32 s52, 5
    s_cbranch_scc1 L_wa6
    s_bitcmp1_b32 s54, 5
    s_cbranch_scc0 L_wb6
    s_waitcnt vmcnt(3)
L_wb6:
    s_waitcnt vmcnt(4)
L_wa6:
    s_waitcnt vmcnt(5)
    buffer_load_dwordx4 v[124:127], v1, s[4:7], s32 offen nt
    v_fma_f32 v93, v52, v72, -v13
    v_fma_f32 v85, v56, v72, -v14
    v_permlane16_swap_b32 v92, v84
    v_add_f32 v92, v92, v84
    v_fmac_f32 v93, v53, v73
    v_fmac_f32 v85, v57, v73
    v_add_f32_dpp v92, v92, v92 row_mirror row_mask:0xf bank_mask:0x3
    v_fmac_f32 v93, v54, v74
    v_fmac_f32 v85, v58, v74
    v_fmac_f32 v93, v55, v75
    v_fmac_f32 v85, v59, v75
    s_waitcnt vmcnt(15)
    v_cvt_f32_i32 v68, v128
    v_cvt_f32_i32 v69, v129
    v_cvt_f32_i32 v70, v130
    v_cvt_f32_i32 v71, v131
    ds_add_u32 v22, v20
    s_bitcmp1_b32 s52, 6
    s_cbranch_scc1 L_wa7
    s_bitcmp1_b32 s54, 6
    s_cbranch_scc0 L_wb7
    s_waitcnt vmcnt(3)
L_wb7:
    s_waitcnt vmcnt(4)
L_wa7:
    s_waitcnt vmcnt(5)
    buffer_load_dwordx4 v[128:131], v1, s[4:7], s33 offen nt
    v_fma_f32 v94, v52, v68, -v13
    v_fma_f32 v84, v56, v68, -v14
    v_permlane16_swap_b32 v93, v85
    v_add_f32 v93, v93, v85
    v_fmac_f32 v94, v53, v69
    v_fmac_f32 v84, v57, v69
    v_add_f32_dpp v93, v93, v93 row_mirror row_mask:0xf bank_mask:0x3
    v_fmac_f32 v94, v54, v70
    v_fmac_f32 v84, v58, v70
    v_fmac_f32 v94, v55, v71
    v_fmac_f32 v84, v59, v71
    s_waitcnt vmcnt(15)
    v_cvt_f32_i32 v72, v132
    v_cvt_f32_i32 v73, v133
    v_cvt_f32_i32 v74, v134
    v_cvt_f32_i32 v75, v135
    s_bitcmp1_b32 s52, 7
    s_cbranch_scc1 L_wa8
    s_bitcmp1_b32 s54, 7
    s_cbranch_scc0 L_wb8
    s_waitcnt vmcnt(3)
L_wb8:
    s_waitcnt vmcnt(4)
L_wa8:
    s_waitcnt vmcnt(5)
    buffer_load_dwordx4 v[132:135], v1, s[4:7], s34 offen nt
    v_fma_f32 v95, v52, v72, -v13
    v_fma_f32 v85, v56, v72, -v14
    v_permlane16_swap_b32 v94, v84
    v_add_f32 v94, v94, v84
    v_fmac_f32 v95, v53, v73
    v_fmac_f32 v85, v57, v73
    v_add_f32_dpp v94, v94, v94 row_mirror row_mask:0xf bank_mask:0x3
    v_fmac_f32 v95, v54, v74
    v_fmac_f32 v85, v58, v74
    v_fmac_f32 v95, v55, v75
    v_fmac_f32 v85, v59, v75
    s_waitcnt vmcnt(15)
    v_cvt_f32_i32 v68, v136
    v_cvt_f32_i32 v69, v137
    v_cvt_f32_i32 v70, v138
    v_cvt_f32_i32 v71, v139
    ds_add_u32 v22, v20
    s_bitcmp1_b32 s52, 8
    s_cbranch_scc1 L_wa9
    s_bitcmp1_b32 s54, 8
    s_cbranch_scc0 L_wb9
    s_waitcnt vmcnt(3)
L_wb9:
    s_waitcnt vmcnt(4)
L_wa9:
    s_waitcnt vmcnt(5)
    buffer_load_dwordx4 v[136:139], v1, s[4:7], s35 offen nt
    s_waitcnt lgkmcnt(3)
    s_waitcnt lgkmcnt(2)
    ds_read_b64 v[32:33], v2 offset:768
    ds_read_b64 v[34:35], v2 offset:33536
    v_lshlrev_b32 v76, 16, v28
    v_and_b32 v77, 0xffff0000, v28
    v_lshlrev_b32 v78, 16, v29
    v_and_b32 v79, 0xffff0000, v29
    v_lshlrev_b32 v80, 16, v30
    v_and_b32 v81, 0xffff0000, v30
    v_lshlrev_b32 v82, 16, v31
    v_and_b32 v83, 0xffff0000, v31
    v_mul_f32 v52, v44, v76
    v_mul_f32 v53, v45, v77
    v_mul_f32 v54, v46, v78
    v_mul_f32 v55, v47, v79
    v_mul_f32 v56, v48, v76
    v_mul_f32 v57, v49, v77
    v_mul_f32 v58, v50, v78
    v_mul_f32 v59, v51, v79
    v_mul_f32 v13, v52, v80
    v_mul_f32 v14, v56, v80
    v_fmac_f32 v13, v53, v81
    v_fmac_f32 v14, v57, v81
    v_fmac_f32 v13, v54, v82
    v_fmac_f32 v14, v58, v82
    v_fmac_f32 v13, v55, v83
    v_fmac_f32 v14, v59, v83
    v_fma_f32 v96, v52, v68, -v13
    v_fma_f32 v84, v56, v68, -v14
    v_permlane16_swap_b32 v95, v85
    v_add_f32 v95, v95, v85
    v_fmac_f32 v96, v53, v69
    v_fmac_f32 v84, v57, v69
    v_add_f32_dpp v95, v95, v95 row_mirror row_mask:0xf bank_mask:0x3
    v_fmac_f32 v96, v54, v70
    v_fmac_f32 v84, v58, v70
    v_fmac_f32 v96, v55, v71
    v_fmac_f32 v84, v59, v71
    s_waitcnt vmcnt(15)
    v_cvt_f32_i32 v72, v140
    v_cvt_f32_i32 v73, v141
    v_cvt_f32_i32 v74, v142
    v_cvt_f32_i32 v75, v143
    s_bitcmp1_b32 s52, 9
    s_cbranch_scc1 L_wa10
    s_bitcmp1_b32 s54, 9
    s_cbranch_scc0 L_wb10
    s_waitcnt vmcnt(3)
L_wb10:
    s_waitcnt vmcnt(4)
L_wa10:
    s_waitcnt vmcnt(5)
    buffer_load_dwordx4 v[140:143], v1, s[4:7], s36 offen nt
    v_fma_f32 v97, v52, v72, -v13
    v_fma_f32 v85, v56, v72, -v14
    v_permlane16_swap_b32 v96, v84
    v_add_f32 v96, v96, v84
    v_fmac_f32 v97, v53, v73
    v_fmac_f32 v85, v57, v73
    v_add_f32_dpp v88, v96, v96 row_mirror row_mask:0xf bank_mask:0xc
    v_fmac_f32 v97, v54, v74
    v_fmac_f32 v85, v58, v74
    v_add_f32_dpp v88, v88, v88 row_half_mirror row_mask:0xf bank_mask:0x5
    v_fmac_f32 v97, v55, v75
    v_fmac_f32 v85, v59, v75
    s_waitcnt vmcnt(15)
    v_cvt_f32_i32 v68, v144
    v_cvt_f32_i32 v69, v145
    v_cvt_f32_i32 v70, v146
    v_cvt_f32_i32 v71, v147
    ds_read_b32 v24, v23
    ds_add_u32 v22, v20
    s_bitcmp1_b32 s52, 10
    s_cbranch_scc1 L_wa11
    s_bitcmp1_b32 s54, 10
    s_cbranch_scc0 L_wb11
    s_waitcnt vmcnt(3)
L_wb11:
    s_waitcnt vmcnt(4)
L_wa11:
    s_waitcnt vmcnt(5)
    buffer_load_dwordx4 v[144:147], v1, s[4:7], s37 offen nt
    v_fma_f32 v98, v52, v68, -v13
    v_fma_f32 v84, v56, v68, -v14
    v_permlane16_swap_b32 v97, v85
    v_add_f32 v97, v97, v85
    v_fmac_f32 v98, v53, v69
    v_fmac_f32 v84, v57, v69
    v_add_f32_dpp v89, v97, v97 row_mirror row_mask:0xf bank_mask:0xc
    v_fmac_f32 v98, v54, v70
    v_fmac_f32 v84, v58, v70
    v_add_f32_dpp v89, v89, v89 row_half_mirror row_mask:0xf bank_mask:0x5
    v_fmac_f32 v98, v55, v71
    v_fmac_f32 v84, v59, v71
    s_waitcnt vmcnt(15)
    v_cvt_f32_i32 v72, v148
    v_cvt_f32_i32 v73, v149
    v_cvt_f32_i32 v74, v150
    v_cvt_f32_i32 v75, v151
    s_bitcmp1_b32 s52, 11
    s_cbranch_scc1 L_wa12
    s_bitcmp1_b32 s54, 11
    s_cbranch_scc0 L_wb12
    s_waitcnt vmcnt(3)
L_wb12:
    s_waitcnt vmcnt(4)
L_wa12:
    s_waitcnt vmcnt(5)
    buffer_load_dwordx4 v[148:151], v1, s[4:7], s38 offen nt
    v_fma_f32 v99, v52, v72, -v13
    v_fma_f32 v85, v56, v72, -v14
    v_permlane16_swap_b32 v98, v84
    v_add_f32 v98, v98, v84
    v_fmac_f32 v99, v53, v73
    v_fmac_f32 v85, v57, v73
    v_add_f32_dpp v90, v98, v98 row_mirror row_mask:0xf bank_mask:0xc
    v_fmac_f32 v99, v54, v74
    v_fmac_f32 v85, v58, v74
    v_add_f32_dpp v90, v90, v90 row_half_mirror row_mask:0xf bank_mask:0x5
    v_fmac_f32 v99, v55, v75
    v_fmac_f32 v85, v59, v75
    s_waitcnt vmcnt(15)
    v_cvt_f32_i32 v68, v152
    v_cvt_f32_i32 v69, v153
    v_cvt_f32_i32 v70, v154
    v_cvt_f32_i32 v71, v155
    ds_add_u32 v22, v20
    s_bitcmp1_b32 s52, 12
    s_cbranch_scc1 L_wa13
    s_bitcmp1_b32 s54, 12
    s_cbranch_scc0 L_wb13
    s_waitcnt vmcnt(3)
L_wb13:
    s_waitcnt vmcnt(4)
L_wa13:
    s_waitcnt vmcnt(5)
    buffer_load_dwordx4 v[152:155], v1, s[4:7], s39 offen nt
    s_waitcnt lgkmcnt(4)
    s_waitcnt lgkmcnt(3)
    ds_read_b64 v[28:29], v2 offset:1024
    ds_read_b64 v[30:31], v2 offset:33792
    v_lshlrev_b32 v76, 16, v32
    v_and_b32 v77, 0xffff0000, v32
    v_lshlrev_b32 v78, 16, v33
    v_and_b32 v79, 0xffff0000, v33
    v_lshlrev_b32 v80, 16, v34
    v_and_b32 v81, 0xffff0000, v34
    v_lshlrev_b32 v82, 16, v35
    v_and_b32 v83, 0xffff0000, v35
    v_mul_f32 v52, v44, v76
    v_mul_f32 v53, v45, v77
    v_mul_f32 v54, v46, v78
    v_mul_f32 v55, v47, v79
    v_mul_f32 v56, v48, v76
    v_mul_f32 v57, v49, v77
    v_mul_f32 v58, v50, v78
    v_mul_f32 v59, v51, v79
    v_mul_f32 v13, v52, v80
    v_mul_f32 v14, v56, v80
    v_fmac_f32 v13, v53, v81
    v_fmac_f32 v14, v57, v81
    v_fmac_f32 v13, v54, v82
    v_fmac_f32 v14, v58, v82
    v_fmac_f32 v13, v55, v83
    v_fmac_f32 v14, v59, v83
    v_fma_f32 v100, v52, v68, -v13
    v_fma_f32 v84, v56, v68, -v14
    v_permlane16_swap_b32 v99, v85
    v_add_f32 v99, v99, v85
    v_fmac_f32 v100, v53, v69
    v_fmac_f32 v84, v57, v69
    v_add_f32_dpp v91, v99, v99 row_mirror row_mask:0xf bank_mask:0xc
    v_fmac_f32 v100, v54, v70
    v_fmac_f32 v84, v58, v70
    v_add_f32_dpp v91, v91, v91 row_half_mirror row_mask:0xf bank_mask:0x5
    v_fmac_f32 v100, v55, v71
    v_fmac_f32 v84, v59, v71
    s_waitcnt vmcnt(15)
    v_cvt_f32_i32 v72, v156
    v_cvt_f32_i32 v73, v157
    v_cvt_f32_i32 v74, v158
    v_cvt_f32_i32 v75, v159
    s_bitcmp1_b32 s52, 13
    s_cbranch_scc1 L_wa14
    s_bitcmp1_b32 s54, 13
    s_cbranch_scc0 L_wb14
    s_waitcnt vmcnt(3)
L_wb14:
    s_waitcnt vmcnt(4)
L_wa14:
    s_waitcnt vmcnt(5)
    buffer_load_dwordx4 v[156:159], v1, s[4:7], s40 offen nt
    v_fma_f32 v101, v52, v72, -v13
    v_fma_f32 v85, v56, v72, -v14
    v_permlane16_swap_b32 v100, v84
    v_add_f32 v100, v100, v84
    v_fmac_f32 v101, v53, v73
    v_fmac_f32 v85, v57, v73
    v_add_f32_dpp v92, v100, v100 row_mirror row_mask:0xf bank_mask:0xc
    v_fmac_f32 v101, v54, v74
    v_fmac_f32 v85, v58, v74
    v_add_f32_dpp v88, v92, v92 row_half_mirror row_mask:0xf bank_mask:0xa
    v_fmac_f32 v101, v55, v75
    v_fmac_f32 v85, v59, v75
    v_add_f32_dpp v88, v88, v88 quad_perm:[2,3,0,1] row_mask:0xf bank_mask:0xf
    s_waitcnt vmcnt(15)
    v_cvt_f32_i32 v68, v160
    v_cvt_f32_i32 v69, v161
    v_cvt_f32_i32 v70, v162
    v_cvt_f32_i32 v71, v163
    ds_add_u32 v22, v20
    s_bitcmp1_b32 s52, 14
    s_cbranch_scc1 L_wa15
    s_bitcmp1_b32 s54, 14
    s_cbranch_scc0 L_wb15
    s_waitcnt vmcnt(3)
L_wb15:
    s_waitcnt vmcnt(4)
L_wa15:
    s_waitcnt vmcnt(5)
    buffer_load_dwordx4 v[160:163], v1, s[4:7], s41 offen nt
    v_fma_f32 v102, v52, v68, -v13
    v_fma_f32 v84, v56, v68, -v14
    v_permlane16_swap_b32 v101, v85
    v_add_f32 v101, v101, v85
    v_fmac_f32 v102, v53, v69
    v_fmac_f32 v84, v57, v69
    v_add_f32_dpp v93, v101, v101 row_mirror row_mask:0xf bank_mask:0xc
    v_fmac_f32 v102, v54, v70
    v_fmac_f32 v84, v58, v70
    v_add_f32_dpp v89, v93, v93 row_half_mirror row_mask:0xf bank_mask:0xa
    v_fmac_f32 v102, v55, v71
    v_fmac_f32 v84, v59, v71
    v_add_f32_dpp v89, v89, v89 quad_perm:[2,3,0,1] row_mask:0xf bank_mask:0xf
    s_waitcnt vmcnt(15)
    v_cvt_f32_i32 v72, v164
    v_cvt_f32_i32 v73, v165
    v_cvt_f32_i32 v74, v166
    v_cvt_f32_i32 v75, v167
    s_bitcmp1_b32 s44, 15
    s_cbranch_scc1 L_wu16
    s_bitcmp1_b32 s52, 15
    s_cbranch_scc1 L_wa16
    s_bitcmp1_b32 s54, 15
    s_cbranch_scc0 L_wb16
    s_waitcnt vmcnt(3)
L_wb16:
    s_waitcnt vmcnt(4)
L_wa16:
    s_waitcnt vmcnt(5)
L_wu16:
    s_waitcnt vmcnt(9)
    buffer_load_dwordx4 v[164:167], v1, s[4:7], s42 offen nt
    v_fma_f32 v103, v52, v72, -v13
    v_fma_f32 v85, v56, v72, -v14
    v_permlane16_swap_b32 v102, v84
    v_add_f32 v102, v102, v84
    v_fmac_f32 v103, v53, v73
    v_fmac_f32 v85, v57, v73
    v_add_f32_dpp v94, v102, v102 row_mirror row_mask:0xf bank_mask:0xc
    v_fmac_f32 v103, v54, v74
    v_fmac_f32 v85, v58, v74
    v_add_f32_dpp v90, v94, v94 row_half_mirror row_mask:0xf bank_mask:0xa
    v_fmac_f32 v103, v55, v75
    v_fmac_f32 v85, v59, v75
    v_add_f32_dpp v90, v90, v90 quad_perm:[2,3,0,1] row_mask:0xf bank_mask:0xf
    s_nop 0
    v_permlane16_swap_b32 v103, v85
    v_add_f32 v103, v103, v85
    s_nop 1
    v_add_f32_dpp v95, v103, v103 row_mirror row_mask:0xf bank_mask:0xc
    v_cndmask_b32 v88, v88, v90, s[22:23]
    s_nop 0
    v_add_f32_dpp v91, v95, v95 row_half_mirror row_mask:0xf bank_mask:0xa
    v_add_f32_dpp v88, v88, v88 quad_perm:[1,0,3,2] row_mask:0xf bank_mask:0xf
    s_nop 0
    v_add_f32_dpp v91, v91, v91 quad_perm:[2,3,0,1] row_mask:0xf bank_mask:0xf
    v_cndmask_b32 v89, v89, v91, s[22:23]
    s_nop 1
    v_add_f32_dpp v89, v89, v89 quad_perm:[1,0,3,2] row_mask:0xf bank_mask:0xf
    v_cndmask_b32 v88, v88, v89, s[24:25]
    ds_write_b32 v4, v88 offset:0
    v_max_f32 v5, v5, v88
    s_waitcnt lgkmcnt(6)
    v_add_u32 v24, 0, v24
    v_cmp_gt_i32 s[52:53], v24, v25
    v_sub_u32 v24, 0, v24
    v_cmp_gt_i32 s[54:55], v24, v25
    s_cmp_eq_u32 s18, 31
    s_cselect_b32 s72, 1, 0
    s_mul_i32 s72, s72, 0x0
    s_xor_b32 s72, s72, 0x8000
    s_cmp_eq_u32 s19, 2
    s_cselect_b32 s44, s72, 0
    v_add_u32 v2, 1024, v2
    v_add_u32 v4, 1024, v4
    s_sub_u32 s19, s19, 1
    s_cmp_lg_u32 s19, 0
    s_cbranch_scc1 L_kloop0
L_kdone:
    s_nop 1
    v_max_f32_dpp v5, v5, v5 quad_perm:[1,0,3,2] row_mask:0xf bank_mask:0xf
    s_nop 1
    v_max_f32_dpp v5, v5, v5 quad_perm:[2,3,0,1] row_mask:0xf bank_mask:0xf
    s_nop 1
    v_max_f32_dpp v5, v5, v5 row_half_mirror row_mask:0xf bank_mask:0xf
    s_nop 1
    v_max_f32_dpp v5, v5, v5 row_mirror row_mask:0xf bank_mask:0xf
    v_mov_b32 v76, v5
    s_nop 1
    v_permlane32_swap_b32 v5, v76
    v_max_f32 v5, v5, v76
    s_mul_i32 s72, s20, 7168
    s_lshl_b32 s73, s21, 2
    s_add_u32 s72, s72, s73
    s_add_u32 s72, s72, 119808
    v_lshl_add_u32 v76, v0, 4, s72
    ds_write_b32 v76, v5
    s_add_u32 s20, s20, 1
    s_cmp_lg_u32 s20, 2
    s_cbranch_scc1 L_kout
    v_subrev_u32 v4, 32768, v4
    s_waitcnt lgkmcnt(0)
    ds_read_b32 v8, v4 offset:0
    ds_read_u16_d16_hi v9, v3 offset:0
    ds_read_u16_d16_hi v10, v3 offset:8192
    s_mov_b32 s44, 0
    s_mov_b32 s20, 0
L_vout:
    s_mul_i32 s72, s20, 7168
    s_add_u32 s72, s72, 114688
    v_lshl_add_u32 v80, v0, 4, s72
    ds_read_b128 v[88:91], v80 offset:5120
    v_mov_b32 v60, 0
    v_mov_b32 v61, 0
    v_mov_b32 v62, 0
    v_mov_b32 v63, 0
    v_mov_b32 v64, 0
    v_mov_b32 v65, 0
    v_mov_b32 v66, 0
    v_mov_b32 v67, 0
    v_mov_b32 v6, 0
    v_mov_b32 v7, 0
    s_lshl_b32 s72, s21, 10
    v_add_u32 v77, s72, v80
    s_lshl_b32 s72, s21, 2
    v_add_u32 v78, s72, v80
    s_lshl_b32 s72, s20, 9
    v_lshl_add_u32 v79, v0, 3, s72
L_mwait:
    s_waitcnt lgkmcnt(0)
    v_max3_u32 v76, v88, v89, v90
    v_max3_f32 v5, v88, v89, v90
    v_max_u32 v76, v76, v91
    v_max_f32 v5, v5, v91
    v_cmp_eq_u32 vcc, -1, v76
    s_cbranch_vccz L_mok
    ds_read_b128 v[88:91], v80 offset:5120
    s_branch L_mwait
L_mok:
    s_mov_b32 s19, 16
L_vloop_disp:
.p2align 6
L_vloop0:
    s_waitcnt vmcnt(15)
    v_cvt_f32_i32 v68, v104
    v_cvt_f32_i32 v69, v105
    v_cvt_f32_i32 v70, v106
    v_cvt_f32_i32 v71, v107
    ds_add_u32 v22, v20
    s_add_u32 s4, s4, 0x10000
    s_addc_u32 s5, s5, 0
    s_add_u32 s18, s18, 1
    s_cmp_eq_u32 s18, 32
    s_cselect_b32 s4, s16, s4
    s_cselect_b32 s5, s17, s5
    s_cmp_ge_u32 s18, 64
    s_cselect_b32 s6, 0, 0x10000
    s_bitcmp1_b32 s44, 0
    s_cbranch_scc1 L_wu17
    s_bitcmp1_b32 s52, 0
    s_cbranch_scc1 L_wa17
    s_bitcmp1_b32 s54, 0
    s_cbranch_scc0 L_wb17
    s_waitcnt vmcnt(3)
L_wb17:
    s_waitcnt vmcnt(4)
L_wa17:
    s_waitcnt vmcnt(5)
L_wu17:
    s_waitcnt vmcnt(9)
    buffer_load_dwordx4 v[104:107], v1, s[4:7], 0 offen nt
    s_waitcnt lgkmcnt(1)
    v_sub_f32 v101, v8, v5
    v_exp_f32 v101, v101
    s_nop 0
    v_mul_f32 v96, v101, v9
    v_add_f32 v6, v6, v101
    v_mov_b32 v97, v96
    v_fmac_f32 v7, v96, v10
    ds_read_b32 v8, v4 offset:1024
    ds_read_u16_d16_hi v9, v3 offset:256
    ds_read_u16_d16_hi v10, v3 offset:8448
    v_permlane16_swap_b32 v96, v97
    s_nop 1
    v_fmac_f32_dpp v60, v96, v68 row_newbcast:0 row_mask:0xf bank_mask:0xf
    v_fmac_f32_dpp v64, v97, v68 row_newbcast:0 row_mask:0xf bank_mask:0xf
    v_fmac_f32_dpp v61, v96, v69 row_newbcast:0 row_mask:0xf bank_mask:0xf
    v_fmac_f32_dpp v65, v97, v69 row_newbcast:0 row_mask:0xf bank_mask:0xf
    v_fmac_f32_dpp v62, v96, v70 row_newbcast:0 row_mask:0xf bank_mask:0xf
    v_fmac_f32_dpp v66, v97, v70 row_newbcast:0 row_mask:0xf bank_mask:0xf
    v_fmac_f32_dpp v63, v96, v71 row_newbcast:0 row_mask:0xf bank_mask:0xf
    v_fmac_f32_dpp v67, v97, v71 row_newbcast:0 row_mask:0xf bank_mask:0xf
    s_waitcnt vmcnt(15)
    v_cvt_f32_i32 v72, v108
    v_cvt_f32_i32 v73, v109
    v_cvt_f32_i32 v74, v110
    v_cvt_f32_i32 v75, v111
    s_bitcmp1_b32 s44, 1
    s_cbranch_scc1 L_wu18
    s_bitcmp1_b32 s52, 1
    s_cbranch_scc1 L_wa18
    s_bitcmp1_b32 s54, 1
    s_cbranch_scc0 L_wb18
    s_waitcnt vmcnt(3)
L_wb18:
    s_waitcnt vmcnt(4)
L_wa18:
    s_waitcnt vmcnt(5)
L_wu18:
    s_waitcnt vmcnt(9)
    buffer_load_dwordx4 v[108:111], v1, s[4:7], s28 offen nt
    v_fmac_f32_dpp v60, v96, v72 row_newbcast:1 row_mask:0xf bank_mask:0xf
    v_fmac_f32_dpp v64, v97, v72 row_newbcast:1 row_mask:0xf bank_mask:0xf
    v_fmac_f32_dpp v61, v96, v73 row_newbcast:1 row_mask:0xf bank_mask:0xf
    v_fmac_f32_dpp v65, v97, v73 row_newbcast:1 row_mask:0xf bank_mask:0xf
    v_fmac_f32_dpp v62, v96, v74 row_newbcast:1 row_mask:0xf bank_mask:0xf
    v_fmac_f32_dpp v66, v97, v74 row_newbcast:1 row_mask:0xf bank_mask:0xf
    v_fmac_f32_dpp v63, v96, v75 row_newbcast:1 row_mask:0xf bank_mask:0xf
    v_fmac_f32_dpp v67, v97, v75 row_newbcast:1 row_mask:0xf bank_mask:0xf
    s_waitcnt vmcnt(15)
    v_cvt_f32_i32 v68, v112
    v_cvt_f32_i32 v69, v113
    v_cvt_f32_i32 v70, v114
    v_cvt_f32_i32 v71, v115
    ds_add_u32 v22, v20
    s_bitcmp1_b32 s44, 2
    s_cbranch_scc1 L_wu19
    s_bitcmp1_b32 s52, 2
    s_cbranch_scc1 L_wa19
    s_bitcmp1_b32 s54, 2
    s_cbranch_scc0 L_wb19
    s_waitcnt vmcnt(3)
L_wb19:
    s_waitcnt vmcnt(4)
L_wa19:
    s_waitcnt vmcnt(5)
L_wu19:
    s_waitcnt vmcnt(9)
    buffer_load_dwordx4 v[112:115], v1, s[4:7], s29 offen nt
    v_fmac_f32_dpp v60, v96, v68 row_newbcast:2 row_mask:0xf bank_mask:0xf
    v_fmac_f32_dpp v64, v97, v68 row_newbcast:2 row_mask:0xf bank_mask:0xf
    v_fmac_f32_dpp v61, v96, v69 row_newbcast:2 row_mask:0xf bank_mask:0xf
    v_fmac_f32_dpp v65, v97, v69 row_newbcast:2 row_mask:0xf bank_mask:0xf
    v_fmac_f32_dpp v62, v96, v70 row_newbcast:2 row_mask:0xf bank_mask:0xf
    v_fmac_f32_dpp v66, v97, v70 row_newbcast:2 row_mask:0xf bank_mask:0xf
    v_fmac_f32_dpp v63, v96, v71 row_newbcast:2 row_mask:0xf bank_mask:0xf
    v_fmac_f32_dpp v67, v97, v71 row_newbcast:2 row_mask:0xf bank_mask:0xf
    s_waitcnt vmcnt(15)
    v_cvt_f32_i32 v72, v116
    v_cvt_f32_i32 v73, v117
    v_cvt_f32_i32 v74, v118
    v_cvt_f32_i32 v75, v119
    s_bitcmp1_b32 s44, 3
    s_cbranch_scc1 L_wu20
    s_bitcmp1_b32 s52, 3
    s_cbranch_scc1 L_wa20
    s_bitcmp1_b32 s54, 3
    s_cbranch_scc0 L_wb20
    s_waitcnt vmcnt(3)
L_wb20:
    s_waitcnt vmcnt(4)
L_wa20:
    s_waitcnt vmcnt(5)
L_wu20:
    s_waitcnt vmcnt(9)
    buffer_load_dwordx4 v[116:119], v1, s[4:7], s30 offen nt
    v_fmac_f32_dpp v60, v96, v72 row_newbcast:3 row_mask:0xf bank_mask:0xf
    v_fmac_f32_dpp v64, v97, v72 row_newbcast:3 row_mask:0xf bank_mask:0xf
    v_fmac_f32_dpp v61, v96, v73 row_newbcast:3 row_mask:0xf bank_mask:0xf
    v_fmac_f32_dpp v65, v97, v73 row_newbcast:3 row_mask:0xf bank_mask:0xf
    v_fmac_f32_dpp v62, v96, v74 row_newbcast:3 row_mask:0xf bank_mask:0xf
    v_fmac_f32_dpp v66, v97, v74 row_newbcast:3 row_mask:0xf bank_mask:0xf
    v_fmac_f32_dpp v63, v96, v75 row_newbcast:3 row_mask:0xf bank_mask:0xf
    v_fmac_f32_dpp v67, v97, v75 row_newbcast:3 row_mask:0xf bank_mask:0xf
    s_waitcnt vmcnt(15)
    v_cvt_f32_i32 v68, v120
    v_cvt_f32_i32 v69, v121
    v_cvt_f32_i32 v70, v122
    v_cvt_f32_i32 v71, v123
    ds_add_u32 v22, v20
    s_bitcmp1_b32 s44, 4
    s_cbranch_scc1 L_wu21
    s_bitcmp1_b32 s52, 4
    s_cbranch_scc1 L_wa21
    s_bitcmp1_b32 s54, 4
    s_cbranch_scc0 L_wb21
    s_waitcnt vmcnt(3)
L_wb21:
    s_waitcnt vmcnt(4)
L_wa21:
    s_waitcnt vmcnt(5)
L_wu21:
    s_waitcnt vmcnt(9)
    buffer_load_dwordx4 v[120:123], v1, s[4:7], s31 offen nt
    v_fmac_f32_dpp v60, v96, v68 row_newbcast:4 row_mask:0xf bank_mask:0xf
    v_fmac_f32_dpp v64, v97, v68 row_newbcast:4 row_mask:0xf bank_mask:0xf
    v_fmac_f32_dpp v61, v96, v69 row_newbcast:4 row_mask:0xf bank_mask:0xf
    v_fmac_f32_dpp v65, v97, v69 row_newbcast:4 row_mask:0xf bank_mask:0xf
    v_fmac_f32_dpp v62, v96, v70 row_newbcast:4 row_mask:0xf bank_mask:0xf
    v_fmac_f32_dpp v66, v97, v70 row_newbcast:4 row_mask:0xf bank_mask:0xf
    v_fmac_f32_dpp v63, v96, v71 row_newbcast:4 row_mask:0xf bank_mask:0xf
    v_fmac_f32_dpp v67, v97, v71 row_newbcast:4 row_mask:0xf bank_mask:0xf
    s_waitcnt vmcnt(15)
    v_cvt_f32_i32 v72, v124
    v_cvt_f32_i32 v73, v125
    v_cvt_f32_i32 v74, v126
    v_cvt_f32_i32 v75, v127
    s_bitcmp1_b32 s44, 5
    s_cbranch_scc1 L_wu22
    s_bitcmp1_b32 s52, 5
    s_cbranch_scc1 L_wa22
    s_bitcmp1_b32 s54, 5
    s_cbranch_scc0 L_wb22
    s_waitcnt vmcnt(3)
L_wb22:
    s_waitcnt vmcnt(4)
L_wa22:
    s_waitcnt vmcnt(5)
L_wu22:
    s_waitcnt vmcnt(9)
    buffer_load_dwordx4 v[124:127], v1, s[4:7], s32 offen nt
    v_fmac_f32_dpp v60, v96, v72 row_newbcast:5 row_mask:0xf bank_mask:0xf
    v_fmac_f32_dpp v64, v97, v72 row_newbcast:5 row_mask:0xf bank_mask:0xf
    v_fmac_f32_dpp v61, v96, v73 row_newbcast:5 row_mask:0xf bank_mask:0xf
    v_fmac_f32_dpp v65, v97, v73 row_newbcast:5 row_mask:0xf bank_mask:0xf
    v_fmac_f32_dpp v62, v96, v74 row_newbcast:5 row_mask:0xf bank_mask:0xf
    v_fmac_f32_dpp v66, v97, v74 row_newbcast:5 row_mask:0xf bank_mask:0xf
    v_fmac_f32_dpp v63, v96, v75 row_newbcast:5 row_mask:0xf bank_mask:0xf
    v_fmac_f32_dpp v67, v97, v75 row_newbcast:5 row_mask:0xf bank_mask:0xf
    s_waitcnt vmcnt(15)
    v_cvt_f32_i32 v68, v128
    v_cvt_f32_i32 v69, v129
    v_cvt_f32_i32 v70, v130
    v_cvt_f32_i32 v71, v131
    ds_add_u32 v22, v20
    s_bitcmp1_b32 s44, 6
    s_cbranch_scc1 L_wu23
    s_bitcmp1_b32 s52, 6
    s_cbranch_scc1 L_wa23
    s_bitcmp1_b32 s54, 6
    s_cbranch_scc0 L_wb23
    s_waitcnt vmcnt(3)
L_wb23:
    s_waitcnt vmcnt(4)
L_wa23:
    s_waitcnt vmcnt(5)
L_wu23:
    s_waitcnt vmcnt(9)
    buffer_load_dwordx4 v[128:131], v1, s[4:7], s33 offen nt
    v_fmac_f32_dpp v60, v96, v68 row_newbcast:6 row_mask:0xf bank_mask:0xf
    v_fmac_f32_dpp v64, v97, v68 row_newbcast:6 row_mask:0xf bank_mask:0xf
    v_fmac_f32_dpp v61, v96, v69 row_newbcast:6 row_mask:0xf bank_mask:0xf
    v_fmac_f32_dpp v65, v97, v69 row_newbcast:6 row_mask:0xf bank_mask:0xf
    v_fmac_f32_dpp v62, v96, v70 row_newbcast:6 row_mask:0xf bank_mask:0xf
    v_fmac_f32_dpp v66, v97, v70 row_newbcast:6 row_mask:0xf bank_mask:0xf
    v_fmac_f32_dpp v63, v96, v71 row_newbcast:6 row_mask:0xf bank_mask:0xf
    v_fmac_f32_dpp v67, v97, v71 row_newbcast:6 row_mask:0xf bank_mask:0xf
    s_waitcnt vmcnt(15)
    v_cvt_f32_i32 v72, v132
    v_cvt_f32_i32 v73, v133
    v_cvt_f32_i32 v74, v134
    v_cvt_f32_i32 v75, v135
    s_bitcmp1_b32 s44, 7
    s_cbranch_scc1 L_wu24
    s_bitcmp1_b32 s52, 7
    s_cbranch_scc1 L_wa24
    s_bitcmp1_b32 s54, 7
    s_cbranch_scc0 L_wb24
    s_waitcnt vmcnt(3)
L_wb24:
    s_waitcnt vmcnt(4)
L_wa24:
    s_waitcnt vmcnt(5)
L_wu24:
    s_waitcnt vmcnt(9)
    buffer_load_dwordx4 v[132:135], v1, s[4:7], s34 offen nt
    v_fmac_f32_dpp v60, v96, v72 row_newbcast:7 row_mask:0xf bank_mask:0xf
    v_fmac_f32_dpp v64, v97, v72 row_newbcast:7 row_mask:0xf bank_mask:0xf
    v_fmac_f32_dpp v61, v96, v73 row_newbcast:7 row_mask:0xf bank_mask:0xf
    v_fmac_f32_dpp v65, v97, v73 row_newbcast:7 row_mask:0xf bank_mask:0xf
    v_fmac_f32_dpp v62, v96, v74 row_newbcast:7 row_mask:0xf bank_mask:0xf
    v_fmac_f32_dpp v66, v97, v74 row_newbcast:7 row_mask:0xf bank_mask:0xf
    v_fmac_f32_dpp v63, v96, v75 row_newbcast:7 row_mask:0xf bank_mask:0xf
    v_fmac_f32_dpp v67, v97, v75 row_newbcast:7 row_mask:0xf bank_mask:0xf
    s_waitcnt vmcnt(15)
    v_cvt_f32_i32 v68, v136
    v_cvt_f32_i32 v69, v137
    v_cvt_f32_i32 v70, v138
    v_cvt_f32_i32 v71, v139
    ds_add_u32 v22, v20
    s_bitcmp1_b32 s44, 8
    s_cbranch_scc1 L_wu25
    s_bitcmp1_b32 s52, 8
    s_cbranch_scc1 L_wa25
    s_bitcmp1_b32 s54, 8
    s_cbranch_scc0 L_wb25
    s_waitcnt vmcnt(3)
L_wb25:
    s_waitcnt vmcnt(4)
L_wa25:
    s_waitcnt vmcnt(5)
L_wu25:
    s_waitcnt vmcnt(9)
    buffer_load_dwordx4 v[136:139], v1, s[4:7], s35 offen nt
    v_fmac_f32_dpp v60, v96, v68 row_newbcast:8 row_mask:0xf bank_mask:0xf
    v_fmac_f32_dpp v64, v97, v68 row_newbcast:8 row_mask:0xf bank_mask:0xf
    v_fmac_f32_dpp v61, v96, v69 row_newbcast:8 row_mask:0xf bank_mask:0xf
    v_fmac_f32_dpp v65, v97, v69 row_newbcast:8 row_mask:0xf bank_mask:0xf
    v_fmac_f32_dpp v62, v96, v70 row_newbcast:8 row_mask:0xf bank_mask:0xf
    v_fmac_f32_dpp v66, v97, v70 row_newbcast:8 row_mask:0xf bank_mask:0xf
    v_fmac_f32_dpp v63, v96, v71 row_newbcast:8 row_mask:0xf bank_mask:0xf
    v_fmac_f32_dpp v67, v97, v71 row_newbcast:8 row_mask:0xf bank_mask:0xf
    s_waitcnt vmcnt(15)
    v_cvt_f32_i32 v72, v140
    v_cvt_f32_i32 v73, v141
    v_cvt_f32_i32 v74, v142
    v_cvt_f32_i32 v75, v143
    s_bitcmp1_b32 s44, 9
    s_cbranch_scc1 L_wu26
    s_bitcmp1_b32 s52, 9
    s_cbranch_scc1 L_wa26
    s_bitcmp1_b32 s54, 9
    s_cbranch_scc0 L_wb26
    s_waitcnt vmcnt(3)
L_wb26:
    s_waitcnt vmcnt(4)
L_wa26:
    s_waitcnt vmcnt(5)
L_wu26:
    s_waitcnt vmcnt(9)
    buffer_load_dwordx4 v[140:143], v1, s[4:7], s36 offen nt
    v_fmac_f32_dpp v60, v96, v72 row_newbcast:9 row_mask:0xf bank_mask:0xf
    v_fmac_f32_dpp v64, v97, v72 row_newbcast:9 row_mask:0xf bank_mask:0xf
    v_fmac_f32_dpp v61, v96, v73 row_newbcast:9 row_mask:0xf bank_mask:0xf
    v_fmac_f32_dpp v65, v97, v73 row_newbcast:9 row_mask:0xf bank_mask:0xf
    v_fmac_f32_dpp v62, v96, v74 row_newbcast:9 row_mask:0xf bank_mask:0xf
    v_fmac_f32_dpp v66, v97, v74 row_newbcast:9 row_mask:0xf bank_mask:0xf
    v_fmac_f32_dpp v63, v96, v75 row_newbcast:9 row_mask:0xf bank_mask:0xf
    v_fmac_f32_dpp v67, v97, v75 row_newbcast:9 row_mask:0xf bank_mask:0xf
    s_waitcnt vmcnt(15)
    v_cvt_f32_i32 v68, v144
    v_cvt_f32_i32 v69, v145
    v_cvt_f32_i32 v70, v146
    v_cvt_f32_i32 v71, v147
    ds_read_b32 v18, v23 offset:16
    ds_read_b32 v24, v23
    ds_add_u32 v22, v20
    s_bitcmp1_b32 s44, 10
    s_cbranch_scc1 L_wu27
    s_bitcmp1_b32 s52, 10
    s_cbranch_scc1 L_wa27
    s_bitcmp1_b32 s54, 10
    s_cbranch_scc0 L_wb27
    s_waitcnt vmcnt(3)
L_wb27:
    s_waitcnt vmcnt(4)
L_wa27:
    s_waitcnt vmcnt(5)
L_wu27:
    s_waitcnt vmcnt(9)
    buffer_load_dwordx4 v[144:147], v1, s[4:7], s37 offen nt
    v_fmac_f32_dpp v60, v96, v68 row_newbcast:10 row_mask:0xf bank_mask:0xf
    v_fmac_f32_dpp v64, v97, v68 row_newbcast:10 row_mask:0xf bank_mask:0xf
    v_fmac_f32_dpp v61, v96, v69 row_newbcast:10 row_mask:0xf bank_mask:0xf
    v_fmac_f32_dpp v65, v97, v69 row_newbcast:10 row_mask:0xf bank_mask:0xf
    v_fmac_f32_dpp v62, v96, v70 row_newbcast:10 row_mask:0xf bank_mask:0xf
    v_fmac_f32_dpp v66, v97, v70 row_newbcast:10 row_mask:0xf bank_mask:0xf
    v_fmac_f32_dpp v63, v96, v71 row_newbcast:10 row_mask:0xf bank_mask:0xf
    v_fmac_f32_dpp v67, v97, v71 row_newbcast:10 row_mask:0xf bank_mask:0xf
    s_waitcnt vmcnt(15)
    v_cvt_f32_i32 v72, v148
    v_cvt_f32_i32 v73, v149
    v_cvt_f32_i32 v74, v150
    v_cvt_f32_i32 v75, v151
    s_bitcmp1_b32 s44, 11
    s_cbranch_scc1 L_wu28
    s_bitcmp1_b32 s52, 11
    s_cbranch_scc1 L_wa28
    s_bitcmp1_b32 s54, 11
    s_cbranch_scc0 L_wb28
    s_waitcnt vmcnt(3)
L_wb28:
    s_waitcnt vmcnt(4)
L_wa28:
    s_waitcnt vmcnt(5)
L_wu28:
    s_waitcnt vmcnt(9)
    buffer_load_dwordx4 v[148:151], v1, s[4:7], s38 offen nt
    v_fmac_f32_dpp v60, v96, v72 row_newbcast:11 row_mask:0xf bank_mask:0xf
    v_fmac_f32_dpp v64, v97, v72 row_newbcast:11 row_mask:0xf bank_mask:0xf
    v_fmac_f32_dpp v61, v96, v73 row_newbcast:11 row_mask:0xf bank_mask:0xf
    v_fmac_f32_dpp v65, v97, v73 row_newbcast:11 row_mask:0xf bank_mask:0xf
    v_fmac_f32_dpp v62, v96, v74 row_newbcast:11 row_mask:0xf bank_mask:0xf
    v_fmac_f32_dpp v66, v97, v74 row_newbcast:11 row_mask:0xf bank_mask:0xf
    v_fmac_f32_dpp v63, v96, v75 row_newbcast:11 row_mask:0xf bank_mask:0xf
    v_fmac_f32_dpp v67, v97, v75 row_newbcast:11 row_mask:0xf bank_mask:0xf
    s_waitcnt vmcnt(15)
    v_cvt_f32_i32 v68, v152
    v_cvt_f32_i32 v69, v153
    v_cvt_f32_i32 v70, v154
    v_cvt_f32_i32 v71, v155
    ds_add_u32 v22, v20
    s_bitcmp1_b32 s44, 12
    s_cbranch_scc1 L_wu29
    s_bitcmp1_b32 s52, 12
    s_cbranch_scc1 L_wa29
    s_bitcmp1_b32 s54, 12
    s_cbranch_scc0 L_wb29
    s_waitcnt vmcnt(3)
L_wb29:
    s_waitcnt vmcnt(4)
L_wa29:
    s_waitcnt vmcnt(5)
L_wu29:
    s_waitcnt vmcnt(9)
    buffer_load_dwordx4 v[152:155], v1, s[4:7], s39 offen nt
    v_fmac_f32_dpp v60, v96, v68 row_newbcast:12 row_mask:0xf bank_mask:0xf
    v_fmac_f32_dpp v64, v97, v68 row_newbcast:12 row_mask:0xf bank_mask:0xf
    v_fmac_f32_dpp v61, v96, v69 row_newbcast:12 row_mask:0xf bank_mask:0xf
    v_fmac_f32_dpp v65, v97, v69 row_newbcast:12 row_mask:0xf bank_mask:0xf
    v_fmac_f32_dpp v62, v96, v70 row_newbcast:12 row_mask:0xf bank_mask:0xf
    v_fmac_f32_dpp v66, v97, v70 row_newbcast:12 row_mask:0xf bank_mask:0xf
    v_fmac_f32_dpp v63, v96, v71 row_newbcast:12 row_mask:0xf bank_mask:0xf
    v_fmac_f32_dpp v67, v97, v71 row_newbcast:12 row_mask:0xf bank_mask:0xf
    s_waitcnt vmcnt(15)
    v_cvt_f32_i32 v72, v156
    v_cvt_f32_i32 v73, v157
    v_cvt_f32_i32 v74, v158
    v_cvt_f32_i32 v75, v159
    s_bitcmp1_b32 s44, 13
    s_cbranch_scc1 L_wu30
    s_bitcmp1_b32 s52, 13
    s_cbranch_scc1 L_wa30
    s_bitcmp1_b32 s54, 13
    s_cbranch_scc0 L_wb30
    s_waitcnt vmcnt(3)
L_wb30:
    s_waitcnt vmcnt(4)
L_wa30:
    s_waitcnt vmcnt(5)
L_wu30:
    s_waitcnt vmcnt(9)
    buffer_load_dwordx4 v[156:159], v1, s[4:7], s40 offen nt
    v_fmac_f32_dpp v60, v96, v72 row_newbcast:13 row_mask:0xf bank_mask:0xf
    v_fmac_f32_dpp v64, v97, v72 row_newbcast:13 row_mask:0xf bank_mask:0xf
    v_fmac_f32_dpp v61, v96, v73 row_newbcast:13 row_mask:0xf bank_mask:0xf
    v_fmac_f32_dpp v65, v97, v73 row_newbcast:13 row_mask:0xf bank_mask:0xf
    v_fmac_f32_dpp v62, v96, v74 row_newbcast:13 row_mask:0xf bank_mask:0xf
    v_fmac_f32_dpp v66, v97, v74 row_newbcast:13 row_mask:0xf bank_mask:0xf
    v_fmac_f32_dpp v63, v96, v75 row_newbcast:13 row_mask:0xf bank_mask:0xf
    v_fmac_f32_dpp v67, v97, v75 row_newbcast:13 row_mask:0xf bank_mask:0xf
    s_waitcnt vmcnt(15)
    v_cvt_f32_i32 v68, v160
    v_cvt_f32_i32 v69, v161
    v_cvt_f32_i32 v70, v162
    v_cvt_f32_i32 v71, v163
    ds_add_u32 v22, v20
    s_bitcmp1_b32 s44, 14
    s_cbranch_scc1 L_wu31
    s_bitcmp1_b32 s52, 14
    s_cbranch_scc1 L_wa31
    s_bitcmp1_b32 s54, 14
    s_cbranch_scc0 L_wb31
    s_waitcnt vmcnt(3)
L_wb31:
    s_waitcnt vmcnt(4)
L_wa31:
    s_waitcnt vmcnt(5)
L_wu31:
    s_waitcnt vmcnt(9)
    buffer_load_dwordx4 v[160:163], v1, s[4:7], s41 offen nt
    v_fmac_f32_dpp v60, v96, v68 row_newbcast:14 row_mask:0xf bank_mask:0xf
    v_fmac_f32_dpp v64, v97, v68 row_newbcast:14 row_mask:0xf bank_mask:0xf
    v_fmac_f32_dpp v61, v96, v69 row_newbcast:14 row_mask:0xf bank_mask:0xf
    v_fmac_f32_dpp v65, v97, v69 row_newbcast:14 row_mask:0xf bank_mask:0xf
    v_fmac_f32_dpp v62, v96, v70 row_newbcast:14 row_mask:0xf bank_mask:0xf
    v_fmac_f32_dpp v66, v97, v70 row_newbcast:14 row_mask:0xf bank_mask:0xf
    v_fmac_f32_dpp v63, v96, v71 row_newbcast:14 row_mask:0xf bank_mask:0xf
    v_fmac_f32_dpp v67, v97, v71 row_newbcast:14 row_mask:0xf bank_mask:0xf
    s_waitcnt vmcnt(15)
    v_cvt_f32_i32 v72, v164
    v_cvt_f32_i32 v73, v165
    v_cvt_f32_i32 v74, v166
    v_cvt_f32_i32 v75, v167
    s_bitcmp1_b32 s44, 15
    s_cbranch_scc1 L_wu32
    s_bitcmp1_b32 s52, 15
    s_cbranch_scc1 L_wa32
    s_bitcmp1_b32 s54, 15
    s_cbranch_scc0 L_wb32
    s_waitcnt vmcnt(3)
L_wb32:
    s_waitcnt vmcnt(4)
L_wa32:
    s_waitcnt vmcnt(5)
L_wu32:
    s_waitcnt vmcnt(9)
    buffer_load_dwordx4 v[164:167], v1, s[4:7], s42 offen nt
    v_fmac_f32_dpp v60, v96, v72 row_newbcast:15 row_mask:0xf bank_mask:0xf
    v_fmac_f32_dpp v64, v97, v72 row_newbcast:15 row_mask:0xf bank_mask:0xf
    v_fmac_f32_dpp v61, v96, v73 row_newbcast:15 row_mask:0xf bank_mask:0xf
    v_fmac_f32_dpp v65, v97, v73 row_newbcast:15 row_mask:0xf bank_mask:0xf
    v_fmac_f32_dpp v62, v96, v74 row_newbcast:15 row_mask:0xf bank_mask:0xf
    v_fmac_f32_dpp v66, v97, v74 row_newbcast:15 row_mask:0xf bank_mask:0xf
    v_fmac_f32_dpp v63, v96, v75 row_newbcast:15 row_mask:0xf bank_mask:0xf
    v_fmac_f32_dpp v67, v97, v75 row_newbcast:15 row_mask:0xf bank_mask:0xf
    s_waitcnt lgkmcnt(3)
    v_add_u32 v24, 0, v24
    v_cmp_gt_i32 s[52:53], v24, v25
    v_sub_u32 v24, 0, v24
    v_cmp_gt_i32 s[54:55], v24, v25
    s_lshl_b32 s72, s18, 4
    s_sub_u32 s72, 1008, s72
    v_add_u32 v18, v18, v0
    v_cmp_le_i32 s[44:45], s72, v18
    s_cmp_eq_u32 s18, 47
    s_cselect_b32 s72, 0xc000, 0
    s_or_b32 s44, s44, s72
    v_add_u32 v3, 256, v3
    v_add_u32 v4, 1024, v4
    s_cmp_ge_u32 s18, 63
    s_cbranch_scc1 L_vtail
    s_sub_u32 s19, s19, 1
    s_cmp_lg_u32 s19, 0
    s_cbranch_scc1 L_vloop0
    v_add_f32_dpp v6, v6, v6 quad_perm:[1,0,3,2] row_mask:0xf bank_mask:0xf
    v_add_f32_dpp v7, v7, v7 quad_perm:[1,0,3,2] row_mask:0xf bank_mask:0xf
    s_nop 0
    v_add_f32_dpp v6, v6, v6 quad_perm:[2,3,0,1] row_mask:0xf bank_mask:0xf
    v_add_f32_dpp v7, v7, v7 quad_perm:[2,3,0,1] row_mask:0xf bank_mask:0xf
    s_nop 0
    v_add_f32_dpp v6, v6, v6 row_half_mirror row_mask:0xf bank_mask:0xf
    v_add_f32_dpp v7, v7, v7 row_half_mirror row_mask:0xf bank_mask:0xf
    s_nop 0
    v_add_f32_dpp v6, v6, v6 row_mirror row_mask:0xf bank_mask:0xf
    v_add_f32_dpp v7, v7, v7 row_mirror row_mask:0xf bank_mask:0xf
    v_mov_b32 v92, v6
    v_mov_b32 v93, v7
    s_nop 0
    v_permlane16_swap_b32 v6, v92
    v_permlane16_swap_b32 v7, v93
    s_nop 0
    v_permlane32_swap_b32 v6, v92
    v_permlane32_swap_b32 v7, v93
    v_add_f32 v6, v6, v92
    v_add_f32 v7, v7, v93
    ds_write_b32 v78, v6 offset:4096
    s_mov_b32 exec_hi, 0
    v_sub_f32 v60, v60, v7
    v_sub_f32 v61, v61, v7
    v_sub_f32 v62, v62, v7
    v_sub_f32 v63, v63, v7
    s_not_b64 exec, exec
    v_sub_f32 v64, v64, v7
    v_sub_f32 v65, v65, v7
    v_sub_f32 v66, v66, v7
    v_sub_f32 v67, v67, v7
    s_mov_b64 exec, -1
    s_branch L_vdone
.p2align 6
L_vtail:
    s_waitcnt lgkmcnt(0)
    v_sub_f32 v101, v8, v5
    v_exp_f32 v101, v101
    s_nop 0
    v_mul_f32 v96, v101, v9
    v_add_f32 v6, v6, v101
    v_mov_b32 v97, v96
    v_fmac_f32 v7, v96, v10
    s_nop 0
    v_permlane16_swap_b32 v96, v97
    v_add_f32_dpp v6, v6, v6 quad_perm:[1,0,3,2] row_mask:0xf bank_mask:0xf
    v_add_f32_dpp v7, v7, v7 quad_perm:[1,0,3,2] row_mask:0xf bank_mask:0xf
    s_nop 0
    v_add_f32_dpp v6, v6, v6 quad_perm:[2,3,0,1] row_mask:0xf bank_mask:0xf
    v_add_f32_dpp v7, v7, v7 quad_perm:[2,3,0,1] row_mask:0xf bank_mask:0xf
    s_nop 0
    v_add_f32_dpp v6, v6, v6 row_half_mirror row_mask:0xf bank_mask:0xf
    v_add_f32_dpp v7, v7, v7 row_half_mirror row_mask:0xf bank_mask:0xf
    s_nop 0
    v_add_f32_dpp v6, v6, v6 row_mirror row_mask:0xf bank_mask:0xf
    v_add_f32_dpp v7, v7, v7 row_mirror row_mask:0xf bank_mask:0xf
    v_mov_b32 v92, v6
    v_mov_b32 v93, v7
    s_nop 0
    v_permlane16_swap_b32 v6, v92
    v_permlane16_swap_b32 v7, v93
    s_nop 0
    v_permlane32_swap_b32 v6, v92
    v_permlane32_swap_b32 v7, v93
    v_add_f32 v6, v6, v92
    v_add_f32 v7, v7, v93
    ds_write_b32 v78, v6 offset:4096
    s_mov_b32 exec_hi, 0
    v_sub_f32 v60, v60, v7
    v_sub_f32 v61, v61, v7
    v_sub_f32 v62, v62, v7
    v_sub_f32 v63, v63, v7
    s_not_b64 exec, exec
    v_sub_f32 v64, v64, v7
    v_sub_f32 v65, v65, v7
    v_sub_f32 v66, v66, v7
    v_sub_f32 v67, v67, v7
    s_mov_b64 exec, -1
    s_waitcnt vmcnt(15)
    v_cvt_f32_i32 v68, v104
    v_cvt_f32_i32 v69, v105
    v_cvt_f32_i32 v70, v106
    v_cvt_f32_i32 v71, v107
    v_fmac_f32_dpp v60, v96, v68 row_newbcast:0 row_mask:0xf bank_mask:0xf
    v_fmac_f32_dpp v64, v97, v68 row_newbcast:0 row_mask:0xf bank_mask:0xf
    v_fmac_f32_dpp v61, v96, v69 row_newbcast:0 row_mask:0xf bank_mask:0xf
    v_fmac_f32_dpp v65, v97, v69 row_newbcast:0 row_mask:0xf bank_mask:0xf
    v_fmac_f32_dpp v62, v96, v70 row_newbcast:0 row_mask:0xf bank_mask:0xf
    v_fmac_f32_dpp v66, v97, v70 row_newbcast:0 row_mask:0xf bank_mask:0xf
    v_fmac_f32_dpp v63, v96, v71 row_newbcast:0 row_mask:0xf bank_mask:0xf
    v_fmac_f32_dpp v67, v97, v71 row_newbcast:0 row_mask:0xf bank_mask:0xf
    s_waitcnt vmcnt(14)
    v_cvt_f32_i32 v72, v108
    v_cvt_f32_i32 v73, v109
    v_cvt_f32_i32 v74, v110
    v_cvt_f32_i32 v75, v111
    v_fmac_f32_dpp v60, v96, v72 row_newbcast:1 row_mask:0xf bank_mask:0xf
    v_fmac_f32_dpp v64, v97, v72 row_newbcast:1 row_mask:0xf bank_mask:0xf
    v_fmac_f32_dpp v61, v96, v73 row_newbcast:1 row_mask:0xf bank_mask:0xf
    v_fmac_f32_dpp v65, v97, v73 row_newbcast:1 row_mask:0xf bank_mask:0xf
    v_fmac_f32_dpp v62, v96, v74 row_newbcast:1 row_mask:0xf bank_mask:0xf
    v_fmac_f32_dpp v66, v97, v74 row_newbcast:1 row_mask:0xf bank_mask:0xf
    v_fmac_f32_dpp v63, v96, v75 row_newbcast:1 row_mask:0xf bank_mask:0xf
    v_fmac_f32_dpp v67, v97, v75 row_newbcast:1 row_mask:0xf bank_mask:0xf
    s_waitcnt vmcnt(13)
    v_cvt_f32_i32 v68, v112
    v_cvt_f32_i32 v69, v113
    v_cvt_f32_i32 v70, v114
    v_cvt_f32_i32 v71, v115
    v_fmac_f32_dpp v60, v96, v68 row_newbcast:2 row_mask:0xf bank_mask:0xf
    v_fmac_f32_dpp v64, v97, v68 row_newbcast:2 row_mask:0xf bank_mask:0xf
    v_fmac_f32_dpp v61, v96, v69 row_newbcast:2 row_mask:0xf bank_mask:0xf
    v_fmac_f32_dpp v65, v97, v69 row_newbcast:2 row_mask:0xf bank_mask:0xf
    v_fmac_f32_dpp v62, v96, v70 row_newbcast:2 row_mask:0xf bank_mask:0xf
    v_fmac_f32_dpp v66, v97, v70 row_newbcast:2 row_mask:0xf bank_mask:0xf
    v_fmac_f32_dpp v63, v96, v71 row_newbcast:2 row_mask:0xf bank_mask:0xf
    v_fmac_f32_dpp v67, v97, v71 row_newbcast:2 row_mask:0xf bank_mask:0xf
    s_waitcnt vmcnt(12)
    v_cvt_f32_i32 v72, v116
    v_cvt_f32_i32 v73, v117
    v_cvt_f32_i32 v74, v118
    v_cvt_f32_i32 v75, v119
    v_fmac_f32_dpp v60, v96, v72 row_newbcast:3 row_mask:0xf bank_mask:0xf
    v_fmac_f32_dpp v64, v97, v72 row_newbcast:3 row_mask:0xf bank_mask:0xf
    v_fmac_f32_dpp v61, v96, v73 row_newbcast:3 row_mask:0xf bank_mask:0xf
    v_fmac_f32_dpp v65, v97, v73 row_newbcast:3 row_mask:0xf bank_mask:0xf
    v_fmac_f32_dpp v62, v96, v74 row_newbcast:3 row_mask:0xf bank_mask:0xf
    v_fmac_f32_dpp v66, v97, v74 row_newbcast:3 row_mask:0xf bank_mask:0xf
    v_fmac_f32_dpp v63, v96, v75 row_newbcast:3 row_mask:0xf bank_mask:0xf
    v_fmac_f32_dpp v67, v97, v75 row_newbcast:3 row_mask:0xf bank_mask:0xf
    s_waitcnt vmcnt(11)
    v_cvt_f32_i32 v68, v120
    v_cvt_f32_i32 v69, v121
    v_cvt_f32_i32 v70, v122
    v_cvt_f32_i32 v71, v123
    v_fmac_f32_dpp v60, v96, v68 row_newbcast:4 row_mask:0xf bank_mask:0xf
    v_fmac_f32_dpp v64, v97, v68 row_newbcast:4 row_mask:0xf bank_mask:0xf
    v_fmac_f32_dpp v61, v96, v69 row_newbcast:4 row_mask:0xf bank_mask:0xf
    v_fmac_f32_dpp v65, v97, v69 row_newbcast:4 row_mask:0xf bank_mask:0xf
    v_fmac_f32_dpp v62, v96, v70 row_newbcast:4 row_mask:0xf bank_mask:0xf
    v_fmac_f32_dpp v66, v97, v70 row_newbcast:4 row_mask:0xf bank_mask:0xf
    v_fmac_f32_dpp v63, v96, v71 row_newbcast:4 row_mask:0xf bank_mask:0xf
    v_fmac_f32_dpp v67, v97, v71 row_newbcast:4 row_mask:0xf bank_mask:0xf
    s_waitcnt vmcnt(10)
    v_cvt_f32_i32 v72, v124
    v_cvt_f32_i32 v73, v125
    v_cvt_f32_i32 v74, v126
    v_cvt_f32_i32 v75, v127
    v_fmac_f32_dpp v60, v96, v72 row_newbcast:5 row_mask:0xf bank_mask:0xf
    v_fmac_f32_dpp v64, v97, v72 row_newbcast:5 row_mask:0xf bank_mask:0xf
    v_fmac_f32_dpp v61, v96, v73 row_newbcast:5 row_mask:0xf bank_mask:0xf
    v_fmac_f32_dpp v65, v97, v73 row_newbcast:5 row_mask:0xf bank_mask:0xf
    v_fmac_f32_dpp v62, v96, v74 row_newbcast:5 row_mask:0xf bank_mask:0xf
    v_fmac_f32_dpp v66, v97, v74 row_newbcast:5 row_mask:0xf bank_mask:0xf
    v_fmac_f32_dpp v63, v96, v75 row_newbcast:5 row_mask:0xf bank_mask:0xf
    v_fmac_f32_dpp v67, v97, v75 row_newbcast:5 row_mask:0xf bank_mask:0xf
    s_waitcnt vmcnt(9)
    v_cvt_f32_i32 v68, v128
    v_cvt_f32_i32 v69, v129
    v_cvt_f32_i32 v70, v130
    v_cvt_f32_i32 v71, v131
    v_fmac_f32_dpp v60, v96, v68 row_newbcast:6 row_mask:0xf bank_mask:0xf
    v_fmac_f32_dpp v64, v97, v68 row_newbcast:6 row_mask:0xf bank_mask:0xf
    v_fmac_f32_dpp v61, v96, v69 row_newbcast:6 row_mask:0xf bank_mask:0xf
    v_fmac_f32_dpp v65, v97, v69 row_newbcast:6 row_mask:0xf bank_mask:0xf
    v_fmac_f32_dpp v62, v96, v70 row_newbcast:6 row_mask:0xf bank_mask:0xf
    v_fmac_f32_dpp v66, v97, v70 row_newbcast:6 row_mask:0xf bank_mask:0xf
    v_fmac_f32_dpp v63, v96, v71 row_newbcast:6 row_mask:0xf bank_mask:0xf
    v_fmac_f32_dpp v67, v97, v71 row_newbcast:6 row_mask:0xf bank_mask:0xf
    s_waitcnt vmcnt(8)
    v_cvt_f32_i32 v72, v132
    v_cvt_f32_i32 v73, v133
    v_cvt_f32_i32 v74, v134
    v_cvt_f32_i32 v75, v135
    v_fmac_f32_dpp v60, v96, v72 row_newbcast:7 row_mask:0xf bank_mask:0xf
    v_fmac_f32_dpp v64, v97, v72 row_newbcast:7 row_mask:0xf bank_mask:0xf
    v_fmac_f32_dpp v61, v96, v73 row_newbcast:7 row_mask:0xf bank_mask:0xf
    v_fmac_f32_dpp v65, v97, v73 row_newbcast:7 row_mask:0xf bank_mask:0xf
    v_fmac_f32_dpp v62, v96, v74 row_newbcast:7 row_mask:0xf bank_mask:0xf
    v_fmac_f32_dpp v66, v97, v74 row_newbcast:7 row_mask:0xf bank_mask:0xf
    v_fmac_f32_dpp v63, v96, v75 row_newbcast:7 row_mask:0xf bank_mask:0xf
    v_fmac_f32_dpp v67, v97, v75 row_newbcast:7 row_mask:0xf bank_mask:0xf
    s_waitcnt vmcnt(7)
    v_cvt_f32_i32 v68, v136
    v_cvt_f32_i32 v69, v137
    v_cvt_f32_i32 v70, v138
    v_cvt_f32_i32 v71, v139
    v_fmac_f32_dpp v60, v96, v68 row_newbcast:8 row_mask:0xf bank_mask:0xf
    v_fmac_f32_dpp v64, v97, v68 row_newbcast:8 row_mask:0xf bank_mask:0xf
    v_fmac_f32_dpp v61, v96, v69 row_newbcast:8 row_mask:0xf bank_mask:0xf
    v_fmac_f32_dpp v65, v97, v69 row_newbcast:8 row_mask:0xf bank_mask:0xf
    v_fmac_f32_dpp v62, v96, v70 row_newbcast:8 row_mask:0xf bank_mask:0xf
    v_fmac_f32_dpp v66, v97, v70 row_newbcast:8 row_mask:0xf bank_mask:0xf
    v_fmac_f32_dpp v63, v96, v71 row_newbcast:8 row_mask:0xf bank_mask:0xf
    v_fmac_f32_dpp v67, v97, v71 row_newbcast:8 row_mask:0xf bank_mask:0xf
    s_waitcnt vmcnt(6)
    v_cvt_f32_i32 v72, v140
    v_cvt_f32_i32 v73, v141
    v_cvt_f32_i32 v74, v142
    v_cvt_f32_i32 v75, v143
    v_fmac_f32_dpp v60, v96, v72 row_newbcast:9 row_mask:0xf bank_mask:0xf
    v_fmac_f32_dpp v64, v97, v72 row_newbcast:9 row_mask:0xf bank_mask:0xf
    v_fmac_f32_dpp v61, v96, v73 row_newbcast:9 row_mask:0xf bank_mask:0xf
    v_fmac_f32_dpp v65, v97, v73 row_newbcast:9 row_mask:0xf bank_mask:0xf
    v_fmac_f32_dpp v62, v96, v74 row_newbcast:9 row_mask:0xf bank_mask:0xf
    v_fmac_f32_dpp v66, v97, v74 row_newbcast:9 row_mask:0xf bank_mask:0xf
    v_fmac_f32_dpp v63, v96, v75 row_newbcast:9 row_mask:0xf bank_mask:0xf
    v_fmac_f32_dpp v67, v97, v75 row_newbcast:9 row_mask:0xf bank_mask:0xf
    s_waitcnt vmcnt(5)
    v_cvt_f32_i32 v68, v144
    v_cvt_f32_i32 v69, v145
    v_cvt_f32_i32 v70, v146
    v_cvt_f32_i32 v71, v147
    v_fmac_f32_dpp v60, v96, v68 row_newbcast:10 row_mask:0xf bank_mask:0xf
    v_fmac_f32_dpp v64, v97, v68 row_newbcast:10 row_mask:0xf bank_mask:0xf
    v_fmac_f32_dpp v61, v96, v69 row_newbcast:10 row_mask:0xf bank_mask:0xf
    v_fmac_f32_dpp v65, v97, v69 row_newbcast:10 row_mask:0xf bank_mask:0xf
    v_fmac_f32_dpp v62, v96, v70 row_newbcast:10 row_mask:0xf bank_mask:0xf
    v_fmac_f32_dpp v66, v97, v70 row_newbcast:10 row_mask:0xf bank_mask:0xf
    v_fmac_f32_dpp v63, v96, v71 row_newbcast:10 row_mask:0xf bank_mask:0xf
    v_fmac_f32_dpp v67, v97, v71 row_newbcast:10 row_mask:0xf bank_mask:0xf
    s_waitcnt vmcnt(4)
    v_cvt_f32_i32 v72, v148
    v_cvt_f32_i32 v73, v149
    v_cvt_f32_i32 v74, v150
    v_cvt_f32_i32 v75, v151
    v_fmac_f32_dpp v60, v96, v72 row_newbcast:11 row_mask:0xf bank_mask:0xf
    v_fmac_f32_dpp v64, v97, v72 row_newbcast:11 row_mask:0xf bank_mask:0xf
    v_fmac_f32_dpp v61, v96, v73 row_newbcast:11 row_mask:0xf bank_mask:0xf
    v_fmac_f32_dpp v65, v97, v73 row_newbcast:11 row_mask:0xf bank_mask:0xf
    v_fmac_f32_dpp v62, v96, v74 row_newbcast:11 row_mask:0xf bank_mask:0xf
    v_fmac_f32_dpp v66, v97, v74 row_newbcast:11 row_mask:0xf bank_mask:0xf
    v_fmac_f32_dpp v63, v96, v75 row_newbcast:11 row_mask:0xf bank_mask:0xf
    v_fmac_f32_dpp v67, v97, v75 row_newbcast:11 row_mask:0xf bank_mask:0xf
    s_waitcnt vmcnt(3)
    v_cvt_f32_i32 v68, v152
    v_cvt_f32_i32 v69, v153
    v_cvt_f32_i32 v70, v154
    v_cvt_f32_i32 v71, v155
    v_fmac_f32_dpp v60, v96, v68 row_newbcast:12 row_mask:0xf bank_mask:0xf
    v_fmac_f32_dpp v64, v97, v68 row_newbcast:12 row_mask:0xf bank_mask:0xf
    v_fmac_f32_dpp v61, v96, v69 row_newbcast:12 row_mask:0xf bank_mask:0xf
    v_fmac_f32_dpp v65, v97, v69 row_newbcast:12 row_mask:0xf bank_mask:0xf
    v_fmac_f32_dpp v62, v96, v70 row_newbcast:12 row_mask:0xf bank_mask:0xf
    v_fmac_f32_dpp v66, v97, v70 row_newbcast:12 row_mask:0xf bank_mask:0xf
    v_fmac_f32_dpp v63, v96, v71 row_newbcast:12 row_mask:0xf bank_mask:0xf
    v_fmac_f32_dpp v67, v97, v71 row_newbcast:12 row_mask:0xf bank_mask:0xf
    s_waitcnt vmcnt(2)
    v_cvt_f32_i32 v72, v156
    v_cvt_f32_i32 v73, v157
    v_cvt_f32_i32 v74, v158
    v_cvt_f32_i32 v75, v159
    v_fmac_f32_dpp v60, v96, v72 row_newbcast:13 row_mask:0xf bank_mask:0xf
    v_fmac_f32_dpp v64, v97, v72 row_newbcast:13 row_mask:0xf bank_mask:0xf
    v_fmac_f32_dpp v61, v96, v73 row_newbcast:13 row_mask:0xf bank_mask:0xf
    v_fmac_f32_dpp v65, v97, v73 row_newbcast:13 row_mask:0xf bank_mask:0xf
    v_fmac_f32_dpp v62, v96, v74 row_newbcast:13 row_mask:0xf bank_mask:0xf
    v_fmac_f32_dpp v66, v97, v74 row_newbcast:13 row_mask:0xf bank_mask:0xf
    v_fmac_f32_dpp v63, v96, v75 row_newbcast:13 row_mask:0xf bank_mask:0xf
    v_fmac_f32_dpp v67, v97, v75 row_newbcast:13 row_mask:0xf bank_mask:0xf
    s_waitcnt vmcnt(1)
    v_cvt_f32_i32 v68, v160
    v_cvt_f32_i32 v69, v161
    v_cvt_f32_i32 v70, v162
    v_cvt_f32_i32 v71, v163
    v_fmac_f32_dpp v60, v96, v68 row_newbcast:14 row_mask:0xf bank_mask:0xf
    v_fmac_f32_dpp v64, v97, v68 row_newbcast:14 row_mask:0xf bank_mask:0xf
    v_fmac_f32_dpp v61, v96, v69 row_newbcast:14 row_mask:0xf bank_mask:0xf
    v_fmac_f32_dpp v65, v97, v69 row_newbcast:14 row_mask:0xf bank_mask:0xf
    v_fmac_f32_dpp v62, v96, v70 row_newbcast:14 row_mask:0xf bank_mask:0xf
    v_fmac_f32_dpp v66, v97, v70 row_newbcast:14 row_mask:0xf bank_mask:0xf
    v_fmac_f32_dpp v63, v96, v71 row_newbcast:14 row_mask:0xf bank_mask:0xf
    v_fmac_f32_dpp v67, v97, v71 row_newbcast:14 row_mask:0xf bank_mask:0xf
    s_waitcnt vmcnt(0)
    v_cvt_f32_i32 v72, v164
    v_cvt_f32_i32 v73, v165
    v_cvt_f32_i32 v74, v166
    v_cvt_f32_i32 v75, v167
    v_fmac_f32_dpp v60, v96, v72 row_newbcast:15 row_mask:0xf bank_mask:0xf
    v_fmac_f32_dpp v64, v97, v72 row_newbcast:15 row_mask:0xf bank_mask:0xf
    v_fmac_f32_dpp v61, v96, v73 row_newbcast:15 row_mask:0xf bank_mask:0xf
    v_fmac_f32_dpp v65, v97, v73 row_newbcast:15 row_mask:0xf bank_mask:0xf
    v_fmac_f32_dpp v62, v96, v74 row_newbcast:15 row_mask:0xf bank_mask:0xf
    v_fmac_f32_dpp v66, v97, v74 row_newbcast:15 row_mask:0xf bank_mask:0xf
    v_fmac_f32_dpp v63, v96, v75 row_newbcast:15 row_mask:0xf bank_mask:0xf
    v_fmac_f32_dpp v67, v97, v75 row_newbcast:15 row_mask:0xf bank_mask:0xf
L_vdone:
    s_nop 1
    v_permlane32_swap_b32 v60, v64
    v_permlane32_swap_b32 v61, v65
    v_permlane32_swap_b32 v62, v66
    v_permlane32_swap_b32 v63, v67
    v_pk_add_f32 v[60:61], v[60:61], v[64:65]
    v_pk_add_f32 v[62:63], v[62:63], v[66:67]
    ds_write_b128 v77, v[60:63]
    ds_add_rtn_u32 v48, v80, v20 offset:6144
    ds_read_b128 v[28:31], v80 offset:4096
    ds_read_b128 v[32:35], v80 offset:0
    ds_read_b128 v[36:39], v80 offset:1024
    ds_read_b128 v[40:43], v80 offset:2048
    ds_read_b128 v[44:47], v80 offset:3072
    s_add_u32 s20, s20, 1
    s_waitcnt lgkmcnt(5)
    v_cmp_eq_u32 vcc, 3, v48
    s_cbranch_vccz L_vnext
    s_nop 0
    s_mov_b64 exec, vcc
    s_waitcnt lgkmcnt(4)
    v_pk_add_f32 v[28:29], v[28:29], v[30:31]
    v_add_f32 v28, v28, v29
    v_rcp_f32 v28, v28
    s_waitcnt lgkmcnt(2)
    v_pk_add_f32 v[32:33], v[32:33], v[36:37]
    v_pk_add_f32 v[34:35], v[34:35], v[38:39]
    s_waitcnt lgkmcnt(0)
    v_pk_add_f32 v[40:41], v[40:41], v[44:45]
    v_pk_add_f32 v[42:43], v[42:43], v[46:47]
    v_pk_add_f32 v[32:33], v[32:33], v[40:41]
    v_pk_add_f32 v[34:35], v[34:35], v[42:43]
    v_pk_mul_f32 v[32:33], v[32:33], v[28:29] op_sel_hi:[1,0]
    v_pk_mul_f32 v[34:35], v[34:35], v[28:29] op_sel_hi:[1,0]
    v_cvt_pk_bf16_f32 v30, v32, v33
    v_cvt_pk_bf16_f32 v31, v34, v35
    buffer_store_dwordx2 v[30:31], v79, s[12:15], 0 offen
    s_mov_b64 exec, -1
L_vnext:
    s_cmp_lg_u32 s20, 2
    s_cbranch_scc1 L_vout
L_end:
    s_endpgm
.p2align 6
L_help:
    s_nop 0
    v_and_b32 v13, 3, v0
    v_lshlrev_b32 v8, 8, v13
    v_add_u32 v8, 0x1f900, v8
    v_lshlrev_b32 v9, 2, v13
    v_add_u32 v9, 0x1f800, v9
    v_lshlrev_b32 v10, 2, v0
    s_lshr_b32 s7, s3, 3
    s_lshl_b32 s72, s7, 1
    v_mov_b32 v11, s72
    s_lshr_b32 s72, s50, 2
    s_add_u32 s72, s72, 128
    v_mov_b32 v15, s72
    s_mov_b32 s16, 0x1a1d1c1e
    s_mov_b32 s17, 0x1b1d1b1e
    s_lshr_b32 s72, s50, 1
    s_lshr_b64 s[16:17], s[16:17], s72
    s_and_b32 s16, s16, 0xff
    s_cmp_lg_u32 s50, 32
    s_cselect_b32 s18, 1, 0
    s_cmp_eq_u32 s7, 0
    s_cselect_b32 s18, s18, 0
    s_mov_b32 s19, 0
    v_mov_b32 v12, 0
    s_mov_b32 s5, 0
    s_mov_b32 s8, 0
    s_mov_b32 s9, 0
    s_mov_b32 s11, 0
    s_cmp_eq_u32 s50, 32
    s_cselect_b32 s11, 1536, 0
    s_cselect_b32 s8, 1536, 0
    v_mov_b32 v14, 0
    v_mov_b32 v21, 0
    v_mov_b32 v23, 0
    s_waitcnt lgkmcnt(0)
    s_barrier
L_hloop:
    ds_read_b32 v1, v8
    s_waitcnt lgkmcnt(0)
    v_add_u32_dpp v2, v1, v1 quad_perm:[1,0,3,2] row_mask:0xf bank_mask:0xf
    s_nop 1
    v_add_u32_dpp v2, v2, v2 quad_perm:[2,3,0,1] row_mask:0xf bank_mask:0xf
    s_mov_b64 exec, 1
    global_store_short v11, v2, s[48:49]
    s_mov_b64 exec, 0x1ffff
    global_load_dword v3, v10, s[48:49] sc0
    s_mov_b64 exec, s[18:19]
    s_cbranch_execz L_hnp
    global_load_dword v14, v10, s[48:49] offset:128 sc1
L_hnp:
    s_mov_b64 exec, -1
    v_readfirstlane_b32 s4, v2
    v_lshlrev_b32 v6, 2, v2
    v_lshlrev_b32 v7, 4, v1
    v_sub_u32 v7, v6, v7
    s_cmp_eq_u32 s18, 0
    s_cbranch_scc1 L_hw0
    s_add_u32 s12, s4, 4
    s_min_u32 s12, s12, 2000
L_hx0:
    ds_read_b32 v30, v8
    s_waitcnt lgkmcnt(0)
    v_add_u32_dpp v30, v30, v30 quad_perm:[1,0,3,2] row_mask:0xf bank_mask:0xf
    s_nop 1
    v_add_u32_dpp v30, v30, v30 quad_perm:[2,3,0,1] row_mask:0xf bank_mask:0xf
    s_nop 0
    v_readfirstlane_b32 s13, v30
    s_nop 1
    s_cmp_lt_u32 s13, s12
    s_cbranch_scc1 L_hx0
    v_mov_b32 v32, v30
    s_waitcnt vmcnt(6)
    v_readfirstlane_b32 s73, v21
    s_nop 1
    s_cmp_eq_u32 s73, s11
    s_cbranch_scc1 L_hy0
    v_and_b32 v30, 0xffff, v20
    v_lshrrev_b32 v31, 16, v20
    v_add_u32 v30, v30, v31
    s_nop 1
    v_add_u32_dpp v30, v30, v30 quad_perm:[1,0,3,2] row_mask:0xf bank_mask:0xf
    s_nop 1
    v_add_u32_dpp v30, v30, v30 quad_perm:[2,3,0,1] row_mask:0xf bank_mask:0xf
    s_nop 1
    v_add_u32_dpp v30, v30, v30 row_half_mirror row_mask:0xf bank_mask:0xf
    s_nop 1
    v_add_u32_dpp v30, v30, v30 row_mirror row_mask:0xf bank_mask:0xf
    s_nop 0
    v_readfirstlane_b32 s72, v30
    s_mov_b32 s11, s73
    s_nop 0
    s_sub_i32 s72, s73, s72
    s_add_i32 s72, s72, 560
    s_max_i32 s72, s72, -768
    s_min_i32 s72, s72, 768
    s_mov_b32 s8, s72
    s_mul_i32 s72, s8, 5
    s_ashr_i32 s72, s72, 5
    v_mov_b32 v17, s72
    s_mov_b64 exec, 1
    global_store_dword v10, v17, s[48:49] offset:64
    s_mov_b64 exec, -1
L_hy0:
    s_mov_b64 exec, 1
    global_store_short v11, v32, s[48:49]
    s_mov_b64 exec, 0xffff
    global_load_dword v20, v10, s[48:49] sc0
    s_mov_b64 exec, 1
    global_load_dword v21, v10, s[48:49] offset:128 sc1
    s_mov_b64 exec, -1
    s_add_u32 s12, s4, 8
    s_min_u32 s12, s12, 2000
L_hx1:
    ds_read_b32 v30, v8
    s_waitcnt lgkmcnt(0)
    v_add_u32_dpp v30, v30, v30 quad_perm:[1,0,3,2] row_mask:0xf bank_mask:0xf
    s_nop 1
    v_add_u32_dpp v30, v30, v30 quad_perm:[2,3,0,1] row_mask:0xf bank_mask:0xf
    s_nop 0
    v_readfirstlane_b32 s13, v30
    s_nop 1
    s_cmp_lt_u32 s13, s12
    s_cbranch_scc1 L_hx1
    v_mov_b32 v32, v30
    s_waitcnt vmcnt(6)
    v_readfirstlane_b32 s73, v23
    s_nop 1
    s_cmp_eq_u32 s73, s11
    s_cbranch_scc1 L_hy1
    v_and_b32 v30, 0xffff, v22
    v_lshrrev_b32 v31, 16, v22
    v_add_u32 v30, v30, v31
    s_nop 1
    v_add_u32_dpp v30, v30, v30 quad_perm:[1,0,3,2] row_mask:0xf bank_mask:0xf
    s_nop 1
    v_add_u32_dpp v30, v30, v30 quad_perm:[2,3,0,1] row_mask:0xf bank_mask:0xf
    s_nop 1
    v_add_u32_dpp v30, v30, v30 row_half_mirror row_mask:0xf bank_mask:0xf
    s_nop 1
    v_add_u32_dpp v30, v30, v30 row_mirror row_mask:0xf bank_mask:0xf
    s_nop 0
    v_readfirstlane_b32 s72, v30
    s_mov_b32 s11, s73
    s_nop 0
    s_sub_i32 s72, s73, s72
    s_add_i32 s72, s72, 560
    s_max_i32 s72, s72, -768
    s_min_i32 s72, s72, 768
    s_mov_b32 s8, s72
    s_mul_i32 s72, s8, 5
    s_ashr_i32 s72, s72, 5
    v_mov_b32 v17, s72
    s_mov_b64 exec, 1
    global_store_dword v10, v17, s[48:49] offset:64
    s_mov_b64 exec, -1
L_hy1:
    s_mov_b64 exec, 1
    global_store_short v11, v32, s[48:49]
    s_mov_b64 exec, 0xffff
    global_load_dword v22, v10, s[48:49] sc0
    s_mov_b64 exec, 1
    global_load_dword v23, v10, s[48:49] offset:128 sc1
    s_mov_b64 exec, -1
    s_waitcnt vmcnt(6)
    s_branch L_hw1
L_hw0:
    s_waitcnt vmcnt(0)
L_hw1:
    v_and_b32 v4, 0xffff, v3
    v_lshrrev_b32 v5, 16, v3
    v_readlane_b32 s6, v3, 16
    v_add_u32 v4, v4, v5
    s_nop 1
    v_add_u32_dpp v4, v4, v4 quad_perm:[1,0,3,2] row_mask:0xf bank_mask:0xf
    s_nop 1
    v_add_u32_dpp v4, v4, v4 quad_perm:[2,3,0,1] row_mask:0xf bank_mask:0xf
    s_nop 1
    v_add_u32_dpp v4, v4, v4 row_half_mirror row_mask:0xf bank_mask:0xf
    s_nop 1
    v_add_u32_dpp v4, v4, v4 row_mirror row_mask:0xf bank_mask:0xf
    s_cmp_lg_u32 s7, 0
    s_cbranch_scc1 L_hnl
    v_readfirstlane_b32 s72, v4
    s_cmp_lg_u32 s18, 0
    s_cbranch_scc1 L_hslave
    s_cmp_lt_u32 s72, s11
    s_cbranch_scc1 L_hnl
    s_add_u32 s11, s11, s8
    s_add_u32 s8, s8, 512
    s_min_u32 s8, s8, 4096
    s_cmp_gt_u32 s72, 60416
    s_cbranch_scc1 L_hnl
    s_mov_b64 exec, 1
    global_store_dword v10, v4, s[48:49] offset:128 sc1
    s_mov_b64 exec, -1
    s_branch L_hnl
L_hslave:
    s_nop 0
    v_readfirstlane_b32 s73, v14
    s_cmp_lt_u32 s4, 1952
    s_cselect_b32 s18, s18, 0
    s_cselect_b32 s7, 0, 1
    s_cmp_eq_u32 s73, s11
    s_cbranch_scc1 L_hnl
    s_mov_b32 s11, s73
    s_sub_i32 s72, s73, s72
    s_add_i32 s72, s72, 560
    s_max_i32 s72, s72, -768
    s_min_i32 s72, s72, 768
    s_mov_b32 s8, s72
    s_mul_i32 s72, s8, 5
    s_ashr_i32 s72, s72, 5
    v_mov_b32 v17, s72
    s_mov_b64 exec, 1
    global_store_dword v10, v17, s[48:49] offset:64
    s_mov_b64 exec, -1
L_hnl:
    s_nop 0
    v_lshrrev_b32 v4, 3, v4
    v_sub_u32 v4, v4, v6
    s_add_i32 s6, s6, s16
    v_add_u32 v4, s6, v4
    s_mov_b32 s72, 85
    v_mul_i32_i24 v16, s72, v4
    s_mov_b32 s72, 85
    v_mad_i32_i24 v16, v7, s72, v16
    v_ashrrev_i32 v16, 8, v16
    v_add_u32 v16, 12, v16
    v_med3_i32 v16, v16, 8, 64
    v_mul_i32_i24 v4, 12, v4
    v_mad_i32_i24 v4, v7, 12, v4
    v_add_u32 v4, 128, v4
    v_ashrrev_i32 v4, 8, v4
    v_med3_i32 v4, v4, -3, 6
    s_cmp_lt_u32 s4, 32
    s_cselect_b32 s72, 0, -1
    v_and_b32 v4, s72, v4
    v_add_u32 v4, s46, v4
    s_mov_b64 exec, 15
    ds_write_b32 v9, v4
    ds_write_b32 v9, v16 offset:16
    s_mov_b64 exec, -1
    s_cmp_lt_u32 s4, 2000
    s_cbranch_scc1 L_hloop
    s_endpgm
.section .rodata,"a"
.p2align 6
.amdhsa_kernel standalone__kv_cache_quant_int4_int2_kv_with_per_channel_or_per_token_scales__sampling_kernel
  .amdhsa_next_free_vgpr 168
  .amdhsa_next_free_sgpr 96
  .amdhsa_accum_offset 168
  .amdhsa_group_segment_fixed_size 0
  .amdhsa_kernarg_size 80
  .amdhsa_user_sgpr_count 2
  .amdhsa_user_sgpr_kernarg_segment_ptr 1
  .amdhsa_system_sgpr_workgroup_id_x 1
.end_amdhsa_kernel
```
